```python
import torch

def _softmax(x, axis=-1):
    return torch.softmax(x, dim=axis)
def _gelu(x):
    return torch.nn.functional.gelu(x, approximate="tanh")
def _silu(x):
    return torch.nn.functional.silu(x)
def _sigmoid(x):
    return torch.sigmoid(x)
def _layernorm(x, axis=-1, eps=1e-5):
    m = x.mean(dim=axis, keepdim=True)
    v = x.var(dim=axis, keepdim=True, unbiased=False)
    return (x - m) / torch.sqrt(v + eps)
def _scatter_add(tgt, idx, src, axis=0):
    return tgt.clone().index_add_(axis, idx, src)
def _segment_sum(src, seg, n):
    out = torch.zeros((n,) + src.shape[1:], dtype=src.dtype)
    return out.index_add_(0, seg, src)
def _pad(x, pw):
    flat = tuple(v for pair in reversed(pw) for v in pair)
    return torch.nn.functional.pad(x, flat)

kernel_name = 'recurrent_scan__gqa_block_cached__glu_gated_swiglu__decode'

def setup_inputs():

    _w = (lambda a: (lambda t: t.to(torch.bfloat16) if t.is_floating_point() else t)(torch.as_tensor(a)))
    def _A_setup():
        B, Sq, D = 1, 1, 512
        Hq, Hkv, Sk, Dh = 32, 8, 65536, 128
        assert Hq % Hkv == 0, (Hq, Hkv)
        return {
            "x": _w((lambda *s: torch.randn(*s, dtype=torch.bfloat16) * 0.4)(B, Sq, D)),
            "k_cache": _w((lambda *s: torch.randn(*s, dtype=torch.bfloat16) * 1.6)(B, Hkv, Sk, Dh)),
            "v_cache": _w((lambda *s: torch.randn(*s, dtype=torch.bfloat16) * 1.6)(B, Hkv, Sk, Dh)),
            "wq": _w((lambda *s: torch.randn(*s, dtype=torch.bfloat16) * 1.6)(D, Hq * Dh) * (D ** -0.5)),
            "wo": _w((lambda *s: torch.randn(*s, dtype=torch.bfloat16) * 1.6)(Hq * Dh, D) * ((Hq * Dh) ** -0.5)),
        }
    _A_in = _A_setup()

    def _B_setup():
        B, S, D, F = 1, 1, 512, 1792
        return {
            "x": _w((lambda *s: torch.randn(*s, dtype=torch.bfloat16) * 0.4)(B, S, D)),
            "w1": _w((lambda *s: torch.randn(*s, dtype=torch.bfloat16) * 1.6)(D, F) * (2.0 / D) ** 0.5),
            "w3": _w((lambda *s: torch.randn(*s, dtype=torch.bfloat16) * 1.6)(D, F) * (2.0 / D) ** 0.5),
            "w2": _w((lambda *s: torch.randn(*s, dtype=torch.bfloat16) * 1.6)(F, D) * (2.0 / F) ** 0.5),
        }
    _B_in = _B_setup()

    return {
        "A_x": _A_in["x"],
        "A_k_cache": _A_in["k_cache"],
        "A_v_cache": _A_in["v_cache"],
        "A_wq": _A_in["wq"],
        "A_wo": _A_in["wo"],
        "B_x": _B_in["x"],
        "B_w1": _B_in["w1"],
        "B_w3": _B_in["w3"],
        "B_w2": _B_in["w2"],
    }

def reference(A_x, A_k_cache, A_v_cache, A_wq, A_wo, B_x, B_w1, B_w3, B_w2):
    def _A_ref(x, k_cache, v_cache, wq, wo):
        B, Sq, D = x.shape
        Hq, Dh = 32, 128
        Hkv = k_cache.shape[1]
        rep = Hq // Hkv
        q = (lambda x, *d: x.permute(*d))((x @ wq).reshape(B, Sq, Hq, Dh), 0, 2, 1, 3)
        k = (lambda x, n, axis: torch.repeat_interleave(x, n, dim=axis))(k_cache, rep, axis=1)
        v = (lambda x, n, axis: torch.repeat_interleave(x, n, dim=axis))(v_cache, rep, axis=1)
        scores = torch.einsum("bhqd,bhkd->bhqk", q, k) * (Dh ** -0.5)
        p = _softmax(scores, axis=-1)
        o = torch.einsum("bhqk,bhkd->bhqd", p, v)
        return (lambda x, *d: x.permute(*d))(o, 0, 2, 1, 3).reshape(B, Sq, Hq * Dh) @ wo

    def _B_ref(x, w1, w3, w2):
        gate = torch.einsum("bsd,df->bsf", x, w1)
        up = torch.einsum("bsd,df->bsf", x, w3)
        h = _silu(gate) * up
        out = torch.einsum("bsf,fd->bsd", h, w2)
        return out

    x = A_x
    xn = _layernorm(x, axis=-1)
    s = _A_ref(xn, A_k_cache, A_v_cache, A_wq, A_wo)
    g = _silu(_B_ref(xn, B_w1, B_w3, B_w2))
    return x + s * g
```

```asm
; @launch grid=(256,1,1) block=(320,1,1) lds=26768
.amdgcn_target "amdgcn-amd-amdhsa--gfx950"
.text
.globl recurrent_scan__gqa_block_cached__glu_gated_swiglu__decode_kernel
.p2align 8
.type recurrent_scan__gqa_block_cached__glu_gated_swiglu__decode_kernel,@function
recurrent_scan__gqa_block_cached__glu_gated_swiglu__decode_kernel:
s_cmp_ge_u32 s2, 256
s_cbranch_scc1 L_exit
s_load_dwordx2 s[28:29], s[0:1], 8
s_load_dwordx16 s[4:19], s[0:1], 0
s_load_dwordx8 s[20:27], s[0:1], 64
v_lshrrev_b32 v1, 6, v0
v_and_b32 v0, 63, v0
v_readfirstlane_b32 s3, v1
s_lshr_b32 s40, s2, 5
s_cmp_eq_u32 s3, 0
s_cbranch_scc1 L_service
v_lshlrev_b32 v3, 9, v0
v_lshlrev_b32 v5, 6, v0
v_lshrrev_b32 v4, 4, v0
v_and_b32 v6, 1, v0
s_xor_b32 s49, s2, s40
s_and_b32 s49, s49, 7
s_lshl3_add_u32 s49, s40, s49
v_and_b32 v3, 0x400, v3
v_and_b32 v5, 0x300, v5
v_lshl_add_u32 v6, v4, 1, v6
s_bfe_u32 s50, s2, 0x10004
s_lshl1_add_u32 s49, s49, s50
s_lshl_b32 s49, s49, 8
v_lshlrev_b32 v6, 4, v6
v_or3_b32 v1, v3, v5, v6
s_bfe_u32 s50, s2, 0x10003
s_lshl2_add_u32 s50, s50, s3
s_add_u32 s49, s49, s50
s_sub_u32 s49, s49, 1
s_lshl_b32 s49, s49, 12
v_add_u32 v250, 128, v1
s_mov_b32 s30, 0x8000000
s_mov_b32 s31, 0x20000
s_waitcnt lgkmcnt(0)
buffer_load_dwordx4 v[108:111], v1, s[28:31], s49 offen offset:0 nt
buffer_load_dwordx4 v[112:115], v250, s[28:31], s49 offen offset:0 nt
buffer_load_dwordx4 v[116:119], v1, s[28:31], s49 offen offset:2048 nt
buffer_load_dwordx4 v[120:123], v250, s[28:31], s49 offen offset:2048 nt
s_lshr_b32 s40, s2, 5
s_and_b32 s41, s2, 31
s_mov_b32 s86, s2
s_mov_b32 s42, 0x05040100
s_mov_b32 s43, 0x07060302
s_mov_b32 s46, 0x000f000f
s_mov_b32 s47, 0x000f000f
s_mov_b32 s59, 0xfffffc00
s_sub_u32 s48, s3, 1
s_add_u32 s50, s49, 32768
s_mov_b32 s62, s49
v_and_b32 v5, 15, v0
v_lshlrev_b32 v6, 4, v5
v_lshl_add_u32 v2, v4, 8, v6
buffer_load_dwordx4 v[124:127], v1, s[28:31], s50 offen offset:0 nt
s_load_dword s44, s[26:27], 0
s_barrier
v_mul_u32_u24 v236, 544, v5
v_lshl_add_u32 v236, v4, 7, v236
s_mul_i32 s55, s48, 2176
v_add_u32 v236, s55, v236
s_lshl_b32 s55, s48, 5
v_lshl_add_u32 v237, v0, 3, s55
s_lshl_b32 s55, s48, 3
v_mov_b32 v239, s55
v_and_b32 v240, 31, v0
v_lshlrev_b32 v240, 4, v240
s_mul_i32 s56, s48, 544
v_add_u32 v238, s56, v240
s_mul_i32 s60, s86, 2176
s_lshl_b32 s56, s48, 9
s_add_u32 s60, s60, s56
s_add_u32 s60, s60, 393216
s_lshl_b32 s61, s86, 5
s_add_u32 s61, s61, s55
s_lshl_b32 s61, s61, 4
s_add_u32 s61, s61, 262144
v_bfe_u32 v5, v0, 2, 1
v_lshl_add_u32 v6, v4, 1, v5
v_lshlrev_b32 v6, 4, v6
v_and_b32 v5, 3, v0
v_lshl_add_u32 v9, v5, 8, v6
s_and_b32 s54, s2, 7
s_lshl_b32 s54, s54, 3
s_bfe_u32 s55, s2, 0x30003
s_add_u32 s54, s54, s55
s_bfe_u32 s55, s2, 0x10006
s_lshl_b32 s56, s54, 3
s_lshl_b32 s57, s55, 2
s_add_u32 s56, s56, s57
s_lshl_b32 s54, s54, 4
s_lshl_b32 s55, s55, 10
s_add_u32 s54, s54, s55
v_add_u32 v5, s56, v4
v_lshlrev_b32 v13, 1, v5
v_mul_u32_u24 v241, 8704, v0
v_add_u32 v241, s54, v241
v_add_u32 v242, 4352, v241
s_mov_b32 s36, s4
s_and_b32 s37, s5, 0xffff
s_mov_b32 s38, 1024
s_mov_b32 s39, 0x20000
buffer_load_ushort v12, v13, s[36:39], 0 offen
v_mov_b32 v76, 0
v_mov_b32 v77, 0
v_mov_b32 v78, 0
v_mov_b32 v79, 0
v_mov_b32 v80, 0
v_mov_b32 v81, 0
v_mov_b32 v82, 0
v_mov_b32 v83, 0
v_mov_b32 v84, 0
v_mov_b32 v85, 0
v_mov_b32 v86, 0
v_mov_b32 v87, 0
v_mov_b32 v88, 0
v_mov_b32 v89, 0
v_mov_b32 v90, 0
v_mov_b32 v91, 0
v_mov_b32 v92, 0
v_mov_b32 v93, 0
v_mov_b32 v94, 0
v_mov_b32 v95, 0
v_mov_b32 v96, 0
v_mov_b32 v97, 0
v_mov_b32 v98, 0
v_mov_b32 v99, 0
v_mov_b32 v100, 0
v_mov_b32 v101, 0
v_mov_b32 v102, 0
v_mov_b32 v103, 0
v_mov_b32 v104, 0
v_mov_b32 v105, 0
v_mov_b32 v106, 0
v_mov_b32 v107, 0
v_mov_b32 v5, 0
v_mov_b32 v6, 0xf149f2ca
s_mov_b32 s52, 0x3fb8aa3b
s_mov_b32 s53, 0x3db504f3
s_mov_b32 s36, s26
s_and_b32 s37, s27, 0xffff
s_mov_b32 s38, 2097152
s_mov_b32 s39, 0x20000
v_mov_b32 v14, 10112
s_lshl_b32 s55, s48, 12
v_lshl_add_u32 v251, v0, 2, s55
v_mov_b32 v248, 0
v_mov_b32 v249, 1
s_mov_b32 s58, 1
s_waitcnt vmcnt(4)
buffer_load_dwordx4 v[128:131], v250, s[28:31], s50 offen offset:0 nt
s_waitcnt vmcnt(4)
buffer_load_dwordx4 v[132:135], v1, s[28:31], s50 offen offset:2048 nt
s_waitcnt vmcnt(4)
buffer_load_dwordx4 v[136:139], v250, s[28:31], s50 offen offset:2048 nt
s_add_u32 s49, s49, 65536
s_add_u32 s50, s50, 65536
s_waitcnt vmcnt(4)
buffer_load_dwordx4 v[140:143], v1, s[28:31], s49 offen offset:0 nt
s_waitcnt vmcnt(4)
buffer_load_dwordx4 v[144:147], v250, s[28:31], s49 offen offset:0 nt
s_waitcnt vmcnt(4)
buffer_load_dwordx4 v[148:151], v1, s[28:31], s49 offen offset:2048 nt
s_waitcnt vmcnt(4)
buffer_load_dwordx4 v[152:155], v250, s[28:31], s49 offen offset:2048 nt
s_waitcnt vmcnt(4)
buffer_load_dwordx4 v[156:159], v1, s[28:31], s50 offen offset:0 nt
s_waitcnt vmcnt(4)
buffer_load_dwordx4 v[160:163], v250, s[28:31], s50 offen offset:0 nt
s_waitcnt vmcnt(4)
buffer_load_dwordx4 v[164:167], v1, s[28:31], s50 offen offset:2048 nt
s_waitcnt vmcnt(4)
buffer_load_dwordx4 v[168:171], v250, s[28:31], s50 offen offset:2048 nt
s_add_u32 s49, s49, 65536
s_add_u32 s50, s50, 65536
s_waitcnt vmcnt(4)
buffer_load_dwordx4 v[172:175], v1, s[28:31], s49 offen offset:0 nt
s_waitcnt vmcnt(4)
buffer_load_dwordx4 v[176:179], v250, s[28:31], s49 offen offset:0 nt
s_waitcnt vmcnt(4)
buffer_load_dwordx4 v[180:183], v1, s[28:31], s49 offen offset:2048 nt
s_waitcnt vmcnt(4)
buffer_load_dwordx4 v[184:187], v250, s[28:31], s49 offen offset:2048 nt
s_waitcnt vmcnt(4)
buffer_load_dwordx4 v[188:191], v1, s[28:31], s50 offen offset:0 nt
s_waitcnt vmcnt(4)
buffer_load_dwordx4 v[192:195], v250, s[28:31], s50 offen offset:0 nt
s_waitcnt vmcnt(4)
buffer_load_dwordx4 v[196:199], v1, s[28:31], s50 offen offset:2048 nt
s_waitcnt vmcnt(4)
buffer_load_dwordx4 v[200:203], v250, s[28:31], s50 offen offset:2048 nt
s_add_u32 s49, s49, 65536
s_add_u32 s50, s50, 65536
s_waitcnt vmcnt(4)
buffer_load_dwordx4 v[204:207], v1, s[28:31], s49 offen offset:0 nt
s_waitcnt vmcnt(4)
buffer_load_dwordx4 v[208:211], v250, s[28:31], s49 offen offset:0 nt
s_waitcnt vmcnt(4)
buffer_load_dwordx4 v[212:215], v1, s[28:31], s49 offen offset:2048 nt
s_waitcnt vmcnt(4)
buffer_load_dwordx4 v[216:219], v250, s[28:31], s49 offen offset:2048 nt
s_waitcnt vmcnt(4)
buffer_load_dwordx4 v[220:223], v1, s[28:31], s50 offen offset:0 nt
s_waitcnt vmcnt(4)
buffer_load_dwordx4 v[224:227], v250, s[28:31], s50 offen offset:0 nt
s_waitcnt vmcnt(4)
buffer_load_dwordx4 v[228:231], v1, s[28:31], s50 offen offset:2048 nt
s_waitcnt vmcnt(4)
buffer_load_dwordx4 v[232:235], v250, s[28:31], s50 offen offset:2048 nt
s_add_u32 s49, s49, 65536
s_add_u32 s50, s50, 65536
s_mov_b32 s45, 4194304
L_qwait:
ds_read_b32 v8, v14
s_sub_u32 s45, s45, 1
s_cbranch_scc1 L_qok
s_waitcnt lgkmcnt(0)
v_cmp_eq_u32 vcc, 0, v8
s_cbranch_vccnz L_qwait
L_qok:
ds_read_b128 v[16:19], v9 offset:0
ds_read_b128 v[20:23], v9 offset:128
s_mov_b32 s51, 0
s_waitcnt vmcnt(24) lgkmcnt(0)
s_mul_i32 s44, s44, 1664525
s_add_u32 s44, s44, 1013904223
v_mov_b32 v14, s44
v_mov_b32 v246, s44
v_mov_b32 v247, s44
L_loopk:
s_cmp_lg_u32 s51, 3
s_cbranch_scc1 L_nsw
s_mov_b32 s28, s8
s_and_b32 s29, s9, 0xffff
v_mov_b32 v1, v2
v_add_u32 v250, 1024, v2
s_mov_b32 s49, s62
s_add_u32 s50, s62, 32768
L_nsw:
v_mfma_f32_16x16x32_bf16 v[28:31], v[108:111], v[16:19], 0
v_mfma_f32_16x16x32_bf16 v[32:35], v[116:119], v[16:19], 0
v_mfma_f32_16x16x32_bf16 v[28:31], v[112:115], v[20:23], v[28:31]
v_mfma_f32_16x16x32_bf16 v[32:35], v[120:123], v[20:23], v[32:35]
s_mov_b64 exec, 1
ds_add_u32 v248, v249 offset:10116
s_mov_b64 exec, -1
ds_read_b32 v7, v248 offset:10120
s_cmp_ge_u32 s58, 2
s_cbranch_scc1 L_m6KA1
s_waitcnt vmcnt(4)
buffer_load_dwordx4 v[108:111], v1, s[28:31], s49 offen offset:0 nt
s_waitcnt vmcnt(4)
buffer_load_dwordx4 v[112:115], v250, s[28:31], s49 offen offset:0 nt
s_waitcnt vmcnt(4)
buffer_load_dwordx4 v[116:119], v1, s[28:31], s49 offen offset:2048 nt
s_waitcnt vmcnt(4)
buffer_load_dwordx4 v[120:123], v250, s[28:31], s49 offen offset:2048 nt
s_branch L_fKA1
L_m6KA1:
s_waitcnt vmcnt(5)
buffer_load_dwordx4 v[108:111], v1, s[28:31], s49 offen offset:0 nt
s_waitcnt vmcnt(5)
buffer_load_dwordx4 v[112:115], v250, s[28:31], s49 offen offset:0 nt
s_waitcnt vmcnt(5)
buffer_load_dwordx4 v[116:119], v1, s[28:31], s49 offen offset:2048 nt
s_waitcnt vmcnt(5)
buffer_load_dwordx4 v[120:123], v250, s[28:31], s49 offen offset:2048 nt
L_fKA1:
v_mfma_f32_16x16x32_bf16 v[36:39], v[124:127], v[16:19], 0
v_mfma_f32_16x16x32_bf16 v[40:43], v[132:135], v[16:19], 0
v_mfma_f32_16x16x32_bf16 v[36:39], v[128:131], v[20:23], v[36:39]
v_mfma_f32_16x16x32_bf16 v[40:43], v[136:139], v[20:23], v[40:43]
v_add_f32_dpp v10, v29, v28 row_shl:4 row_mask:0xf bank_mask:0x1
v_add_f32_dpp v11, v31, v30 row_shl:4 row_mask:0xf bank_mask:0x1
v_add_f32_dpp v10, v32, v33 row_shr:4 row_mask:0xf bank_mask:0x2
v_add_f32_dpp v11, v34, v35 row_shr:4 row_mask:0xf bank_mask:0x2
s_waitcnt lgkmcnt(0)
v_readfirstlane_b32 s58, v7
s_nop 0
s_cmp_ge_u32 s58, 2
s_cbranch_scc1 L_m6KA2
s_waitcnt vmcnt(4)
buffer_load_dwordx4 v[124:127], v1, s[28:31], s50 offen offset:0 nt
s_waitcnt vmcnt(4)
buffer_load_dwordx4 v[128:131], v250, s[28:31], s50 offen offset:0 nt
s_waitcnt vmcnt(4)
buffer_load_dwordx4 v[132:135], v1, s[28:31], s50 offen offset:2048 nt
s_waitcnt vmcnt(4)
buffer_load_dwordx4 v[136:139], v250, s[28:31], s50 offen offset:2048 nt
s_branch L_fKA2
L_m6KA2:
s_waitcnt vmcnt(5)
buffer_load_dwordx4 v[124:127], v1, s[28:31], s50 offen offset:0 nt
s_waitcnt vmcnt(5)
buffer_load_dwordx4 v[128:131], v250, s[28:31], s50 offen offset:0 nt
s_waitcnt vmcnt(5)
buffer_load_dwordx4 v[132:135], v1, s[28:31], s50 offen offset:2048 nt
s_waitcnt vmcnt(5)
buffer_load_dwordx4 v[136:139], v250, s[28:31], s50 offen offset:2048 nt
L_fKA2:
s_add_u32 s49, s49, 65536
s_add_u32 s50, s50, 65536
v_add_f32_dpp v10, v37, v36 row_shl:4 row_mask:0xf bank_mask:0x4
v_add_f32_dpp v11, v39, v38 row_shl:4 row_mask:0xf bank_mask:0x4
v_add_f32_dpp v10, v40, v41 row_shr:4 row_mask:0xf bank_mask:0x8
v_add_f32_dpp v11, v42, v43 row_shr:4 row_mask:0xf bank_mask:0x8
v_cvt_pk_bf16_f32 v10, 0, v10
v_cvt_pk_bf16_f32 v11, 0, v11
v_mul_f32 v10, s53, v10
v_mul_f32 v11, s53, v11
v_max3_f32 v6, v6, v10, v11
v_cvt_pk_bf16_f32 v3, v10, v11
ds_write_b32 v251, v3 offset:10128
v_mfma_f32_16x16x32_bf16 v[28:31], v[140:143], v[16:19], 0
v_mfma_f32_16x16x32_bf16 v[32:35], v[148:151], v[16:19], 0
v_mfma_f32_16x16x32_bf16 v[28:31], v[144:147], v[20:23], v[28:31]
v_mfma_f32_16x16x32_bf16 v[32:35], v[152:155], v[20:23], v[32:35]
s_mov_b64 exec, 1
ds_add_u32 v248, v249 offset:10116
s_mov_b64 exec, -1
ds_read_b32 v7, v248 offset:10120
s_cmp_ge_u32 s58, 2
s_cbranch_scc1 L_m6KA3
s_waitcnt vmcnt(4)
buffer_load_dwordx4 v[140:143], v1, s[28:31], s49 offen offset:0 nt
s_waitcnt vmcnt(4)
buffer_load_dwordx4 v[144:147], v250, s[28:31], s49 offen offset:0 nt
s_waitcnt vmcnt(4)
buffer_load_dwordx4 v[148:151], v1, s[28:31], s49 offen offset:2048 nt
s_waitcnt vmcnt(4)
buffer_load_dwordx4 v[152:155], v250, s[28:31], s49 offen offset:2048 nt
s_branch L_fKA3
L_m6KA3:
s_waitcnt vmcnt(5)
buffer_load_dwordx4 v[140:143], v1, s[28:31], s49 offen offset:0 nt
s_waitcnt vmcnt(5)
buffer_load_dwordx4 v[144:147], v250, s[28:31], s49 offen offset:0 nt
s_waitcnt vmcnt(5)
buffer_load_dwordx4 v[148:151], v1, s[28:31], s49 offen offset:2048 nt
s_waitcnt vmcnt(5)
buffer_load_dwordx4 v[152:155], v250, s[28:31], s49 offen offset:2048 nt
L_fKA3:
v_mfma_f32_16x16x32_bf16 v[36:39], v[156:159], v[16:19], 0
v_mfma_f32_16x16x32_bf16 v[40:43], v[164:167], v[16:19], 0
v_mfma_f32_16x16x32_bf16 v[36:39], v[160:163], v[20:23], v[36:39]
v_mfma_f32_16x16x32_bf16 v[40:43], v[168:171], v[20:23], v[40:43]
v_add_f32_dpp v10, v29, v28 row_shl:4 row_mask:0xf bank_mask:0x1
v_add_f32_dpp v11, v31, v30 row_shl:4 row_mask:0xf bank_mask:0x1
v_add_f32_dpp v10, v32, v33 row_shr:4 row_mask:0xf bank_mask:0x2
v_add_f32_dpp v11, v34, v35 row_shr:4 row_mask:0xf bank_mask:0x2
s_waitcnt lgkmcnt(0)
v_readfirstlane_b32 s58, v7
s_nop 0
s_cmp_ge_u32 s58, 2
s_cbranch_scc1 L_m6KA4
s_waitcnt vmcnt(4)
buffer_load_dwordx4 v[156:159], v1, s[28:31], s50 offen offset:0 nt
s_waitcnt vmcnt(4)
buffer_load_dwordx4 v[160:163], v250, s[28:31], s50 offen offset:0 nt
s_waitcnt vmcnt(4)
buffer_load_dwordx4 v[164:167], v1, s[28:31], s50 offen offset:2048 nt
s_waitcnt vmcnt(4)
buffer_load_dwordx4 v[168:171], v250, s[28:31], s50 offen offset:2048 nt
s_branch L_fKA4
L_m6KA4:
s_waitcnt vmcnt(5)
buffer_load_dwordx4 v[156:159], v1, s[28:31], s50 offen offset:0 nt
s_waitcnt vmcnt(5)
buffer_load_dwordx4 v[160:163], v250, s[28:31], s50 offen offset:0 nt
s_waitcnt vmcnt(5)
buffer_load_dwordx4 v[164:167], v1, s[28:31], s50 offen offset:2048 nt
s_waitcnt vmcnt(5)
buffer_load_dwordx4 v[168:171], v250, s[28:31], s50 offen offset:2048 nt
L_fKA4:
s_add_u32 s49, s49, 65536
s_add_u32 s50, s50, 65536
v_add_f32_dpp v10, v37, v36 row_shl:4 row_mask:0xf bank_mask:0x4
v_add_f32_dpp v11, v39, v38 row_shl:4 row_mask:0xf bank_mask:0x4
v_add_f32_dpp v10, v40, v41 row_shr:4 row_mask:0xf bank_mask:0x8
v_add_f32_dpp v11, v42, v43 row_shr:4 row_mask:0xf bank_mask:0x8
v_cvt_pk_bf16_f32 v10, 0, v10
v_cvt_pk_bf16_f32 v11, 0, v11
v_mul_f32 v10, s53, v10
v_mul_f32 v11, s53, v11
v_max3_f32 v6, v6, v10, v11
v_cvt_pk_bf16_f32 v3, v10, v11
ds_write_b32 v251, v3 offset:10384
v_mfma_f32_16x16x32_bf16 v[28:31], v[172:175], v[16:19], 0
v_mfma_f32_16x16x32_bf16 v[32:35], v[180:183], v[16:19], 0
v_mfma_f32_16x16x32_bf16 v[28:31], v[176:179], v[20:23], v[28:31]
v_mfma_f32_16x16x32_bf16 v[32:35], v[184:187], v[20:23], v[32:35]
s_mov_b64 exec, 1
ds_add_u32 v248, v249 offset:10116
s_mov_b64 exec, -1
ds_read_b32 v7, v248 offset:10120
s_cmp_ge_u32 s58, 2
s_cbranch_scc1 L_m6KB1
s_waitcnt vmcnt(4)
buffer_load_dwordx4 v[172:175], v1, s[28:31], s49 offen offset:0 nt
s_waitcnt vmcnt(4)
buffer_load_dwordx4 v[176:179], v250, s[28:31], s49 offen offset:0 nt
s_waitcnt vmcnt(4)
buffer_load_dwordx4 v[180:183], v1, s[28:31], s49 offen offset:2048 nt
s_waitcnt vmcnt(4)
buffer_load_dwordx4 v[184:187], v250, s[28:31], s49 offen offset:2048 nt
s_branch L_fKB1
L_m6KB1:
s_waitcnt vmcnt(5)
buffer_load_dwordx4 v[172:175], v1, s[28:31], s49 offen offset:0 nt
s_waitcnt vmcnt(5)
buffer_load_dwordx4 v[176:179], v250, s[28:31], s49 offen offset:0 nt
s_waitcnt vmcnt(5)
buffer_load_dwordx4 v[180:183], v1, s[28:31], s49 offen offset:2048 nt
s_waitcnt vmcnt(5)
buffer_load_dwordx4 v[184:187], v250, s[28:31], s49 offen offset:2048 nt
L_fKB1:
v_mfma_f32_16x16x32_bf16 v[36:39], v[188:191], v[16:19], 0
v_mfma_f32_16x16x32_bf16 v[40:43], v[196:199], v[16:19], 0
v_mfma_f32_16x16x32_bf16 v[36:39], v[192:195], v[20:23], v[36:39]
v_mfma_f32_16x16x32_bf16 v[40:43], v[200:203], v[20:23], v[40:43]
v_add_f32_dpp v10, v29, v28 row_shl:4 row_mask:0xf bank_mask:0x1
v_add_f32_dpp v11, v31, v30 row_shl:4 row_mask:0xf bank_mask:0x1
v_add_f32_dpp v10, v32, v33 row_shr:4 row_mask:0xf bank_mask:0x2
v_add_f32_dpp v11, v34, v35 row_shr:4 row_mask:0xf bank_mask:0x2
s_waitcnt lgkmcnt(0)
v_readfirstlane_b32 s58, v7
s_nop 0
s_cmp_ge_u32 s58, 2
s_cbranch_scc1 L_m6KB2
s_waitcnt vmcnt(4)
buffer_load_dwordx4 v[188:191], v1, s[28:31], s50 offen offset:0 nt
s_waitcnt vmcnt(4)
buffer_load_dwordx4 v[192:195], v250, s[28:31], s50 offen offset:0 nt
s_waitcnt vmcnt(4)
buffer_load_dwordx4 v[196:199], v1, s[28:31], s50 offen offset:2048 nt
s_waitcnt vmcnt(4)
buffer_load_dwordx4 v[200:203], v250, s[28:31], s50 offen offset:2048 nt
s_branch L_fKB2
L_m6KB2:
s_waitcnt vmcnt(5)
buffer_load_dwordx4 v[188:191], v1, s[28:31], s50 offen offset:0 nt
s_waitcnt vmcnt(5)
buffer_load_dwordx4 v[192:195], v250, s[28:31], s50 offen offset:0 nt
s_waitcnt vmcnt(5)
buffer_load_dwordx4 v[196:199], v1, s[28:31], s50 offen offset:2048 nt
s_waitcnt vmcnt(5)
buffer_load_dwordx4 v[200:203], v250, s[28:31], s50 offen offset:2048 nt
L_fKB2:
s_add_u32 s49, s49, 65536
s_add_u32 s50, s50, 65536
v_add_f32_dpp v10, v37, v36 row_shl:4 row_mask:0xf bank_mask:0x4
v_add_f32_dpp v11, v39, v38 row_shl:4 row_mask:0xf bank_mask:0x4
v_add_f32_dpp v10, v40, v41 row_shr:4 row_mask:0xf bank_mask:0x8
v_add_f32_dpp v11, v42, v43 row_shr:4 row_mask:0xf bank_mask:0x8
v_cvt_pk_bf16_f32 v10, 0, v10
v_cvt_pk_bf16_f32 v11, 0, v11
v_mul_f32 v10, s53, v10
v_mul_f32 v11, s53, v11
v_max3_f32 v6, v6, v10, v11
v_cvt_pk_bf16_f32 v3, v10, v11
ds_write_b32 v251, v3 offset:10640
v_mfma_f32_16x16x32_bf16 v[28:31], v[204:207], v[16:19], 0
v_mfma_f32_16x16x32_bf16 v[32:35], v[212:215], v[16:19], 0
v_mfma_f32_16x16x32_bf16 v[28:31], v[208:211], v[20:23], v[28:31]
v_mfma_f32_16x16x32_bf16 v[32:35], v[216:219], v[20:23], v[32:35]
s_mov_b64 exec, 1
ds_add_u32 v248, v249 offset:10116
s_mov_b64 exec, -1
ds_read_b32 v7, v248 offset:10120
s_cmp_eq_u32 s51, 3
s_cbranch_scc1 L_ks3a
s_cmp_ge_u32 s58, 2
s_cbranch_scc1 L_m6KB3
s_waitcnt vmcnt(4)
buffer_load_dwordx4 v[204:207], v1, s[28:31], s49 offen offset:0 nt
s_waitcnt vmcnt(4)
buffer_load_dwordx4 v[208:211], v250, s[28:31], s49 offen offset:0 nt
s_waitcnt vmcnt(4)
buffer_load_dwordx4 v[212:215], v1, s[28:31], s49 offen offset:2048 nt
s_waitcnt vmcnt(4)
buffer_load_dwordx4 v[216:219], v250, s[28:31], s49 offen offset:2048 nt
s_branch L_fKB3
L_m6KB3:
s_waitcnt vmcnt(5)
buffer_load_dwordx4 v[204:207], v1, s[28:31], s49 offen offset:0 nt
s_waitcnt vmcnt(5)
buffer_load_dwordx4 v[208:211], v250, s[28:31], s49 offen offset:0 nt
s_waitcnt vmcnt(5)
buffer_load_dwordx4 v[212:215], v1, s[28:31], s49 offen offset:2048 nt
s_waitcnt vmcnt(5)
buffer_load_dwordx4 v[216:219], v250, s[28:31], s49 offen offset:2048 nt
L_fKB3:
L_ks3a:
v_mfma_f32_16x16x32_bf16 v[36:39], v[220:223], v[16:19], 0
v_mfma_f32_16x16x32_bf16 v[40:43], v[228:231], v[16:19], 0
v_mfma_f32_16x16x32_bf16 v[36:39], v[224:227], v[20:23], v[36:39]
v_mfma_f32_16x16x32_bf16 v[40:43], v[232:235], v[20:23], v[40:43]
v_add_f32_dpp v10, v29, v28 row_shl:4 row_mask:0xf bank_mask:0x1
v_add_f32_dpp v11, v31, v30 row_shl:4 row_mask:0xf bank_mask:0x1
v_add_f32_dpp v10, v32, v33 row_shr:4 row_mask:0xf bank_mask:0x2
v_add_f32_dpp v11, v34, v35 row_shr:4 row_mask:0xf bank_mask:0x2
s_waitcnt lgkmcnt(0)
v_readfirstlane_b32 s58, v7
s_cmp_eq_u32 s51, 3
s_cbranch_scc1 L_ks3b
s_cmp_ge_u32 s58, 2
s_cbranch_scc1 L_m6KB4
s_waitcnt vmcnt(4)
buffer_load_dwordx4 v[220:223], v1, s[28:31], s50 offen offset:0 nt
s_waitcnt vmcnt(4)
buffer_load_dwordx4 v[224:227], v250, s[28:31], s50 offen offset:0 nt
s_waitcnt vmcnt(4)
buffer_load_dwordx4 v[228:231], v1, s[28:31], s50 offen offset:2048 nt
s_waitcnt vmcnt(4)
buffer_load_dwordx4 v[232:235], v250, s[28:31], s50 offen offset:2048 nt
s_branch L_fKB4
L_m6KB4:
s_waitcnt vmcnt(5)
buffer_load_dwordx4 v[220:223], v1, s[28:31], s50 offen offset:0 nt
s_waitcnt vmcnt(5)
buffer_load_dwordx4 v[224:227], v250, s[28:31], s50 offen offset:0 nt
s_waitcnt vmcnt(5)
buffer_load_dwordx4 v[228:231], v1, s[28:31], s50 offen offset:2048 nt
s_waitcnt vmcnt(5)
buffer_load_dwordx4 v[232:235], v250, s[28:31], s50 offen offset:2048 nt
L_fKB4:
s_add_u32 s49, s49, 65536
s_add_u32 s50, s50, 65536
L_ks3b:
v_add_f32_dpp v10, v37, v36 row_shl:4 row_mask:0xf bank_mask:0x4
v_add_f32_dpp v11, v39, v38 row_shl:4 row_mask:0xf bank_mask:0x4
v_add_f32_dpp v10, v40, v41 row_shr:4 row_mask:0xf bank_mask:0x8
v_add_f32_dpp v11, v42, v43 row_shr:4 row_mask:0xf bank_mask:0x8
v_cvt_pk_bf16_f32 v10, 0, v10
v_cvt_pk_bf16_f32 v11, 0, v11
v_mul_f32 v10, s53, v10
v_mul_f32 v11, s53, v11
v_max3_f32 v6, v6, v10, v11
v_cvt_pk_bf16_f32 v3, v10, v11
ds_write_b32 v251, v3 offset:10896
v_add_u32 v251, 1024, v251
s_add_u32 s51, s51, 1
s_cmp_lt_u32 s51, 4
s_cbranch_scc1 L_loopk
v_subrev_u32 v251, 4096, v251
ds_read_b32 v15, v251 offset:10128
v_max_f32_dpp v6, v6, v6 row_ror:4 row_mask:0xf bank_mask:0xf
s_nop 1
v_max_f32_dpp v6, v6, v6 row_ror:8 row_mask:0xf bank_mask:0xf
v_mov_b32 v3, v6
s_nop 1
v_permlane16_swap_b32 v6, v3
v_max_f32 v6, v6, v3
v_mov_b32 v3, v6
s_nop 1
v_permlane32_swap_b32 v6, v3
v_max_f32 v6, v6, v3
v_cvt_pk_bf16_f32 v6, 0, v6
v_mul_f32 v4, 0xbfb8aa3b, v6
L_loop:
s_cmp_ge_u32 s51, 6
s_cbranch_scc0 L_lb0
s_barrier
L_lb0:
s_waitcnt lgkmcnt(0)
v_lshlrev_b32 v10, 16, v15
v_and_b32 v11, 0xffff0000, v15
v_readfirstlane_b32 s58, v7
ds_read_b32 v15, v251 offset:10384
s_mov_b64 exec, 1
ds_add_u32 v248, v249 offset:10116
s_mov_b64 exec, -1
ds_read_b32 v7, v248 offset:10120
v_fma_f32 v10, v10, s52, v4
v_fma_f32 v11, v11, s52, v4
v_exp_f32 v10, v10
v_exp_f32 v11, v11
v_perm_b32 v44, v112, v108, s42
v_perm_b32 v48, v112, v108, s43
v_perm_b32 v52, v113, v109, s42
v_perm_b32 v56, v113, v109, s43
v_perm_b32 v60, v114, v110, s42
v_perm_b32 v64, v114, v110, s43
v_perm_b32 v68, v115, v111, s42
v_perm_b32 v72, v115, v111, s43
v_cvt_pk_bf16_f32 v24, v10, v11
v_add_f32 v5, v5, v10
v_add_f32 v5, v5, v11
v_mov_b32_dpp v25, v24 row_shl:4 row_mask:0xf bank_mask:0xf
v_mov_b32_dpp v26, v24 row_shl:8 row_mask:0xf bank_mask:0xf
v_mov_b32_dpp v27, v24 row_shl:12 row_mask:0xf bank_mask:0xf
v_perm_b32 v45, v120, v116, s42
v_perm_b32 v49, v120, v116, s43
v_perm_b32 v53, v121, v117, s42
v_perm_b32 v57, v121, v117, s43
v_perm_b32 v61, v122, v118, s42
v_perm_b32 v65, v122, v118, s43
v_perm_b32 v69, v123, v119, s42
v_perm_b32 v73, v123, v119, s43
s_cmp_ge_u32 s51, 6
s_cbranch_scc0 L_eVA1
s_cmp_eq_u32 s51, 7
s_cbranch_scc0 L_7VA1
s_waitcnt vmcnt(15)
buffer_load_dwordx4 v[204:207], v1, s[28:31], s49 offen offset:0 nt
s_waitcnt vmcnt(15)
buffer_load_dwordx4 v[208:211], v250, s[28:31], s49 offen offset:0 nt
s_waitcnt vmcnt(15)
buffer_load_dwordx4 v[212:215], v1, s[28:31], s49 offen offset:2048 nt
s_waitcnt vmcnt(15)
buffer_load_dwordx4 v[216:219], v250, s[28:31], s49 offen offset:2048 nt
s_branch L_fVA1
L_7VA1:
s_waitcnt vmcnt(6)
buffer_load_dwordx4 v[204:207], v1, s[28:31], s49 offen offset:0 nt
s_waitcnt vmcnt(6)
buffer_load_dwordx4 v[208:211], v250, s[28:31], s49 offen offset:0 nt
s_waitcnt vmcnt(6)
buffer_load_dwordx4 v[212:215], v1, s[28:31], s49 offen offset:2048 nt
s_waitcnt vmcnt(6)
buffer_load_dwordx4 v[216:219], v250, s[28:31], s49 offen offset:2048 nt
s_branch L_fVA1
L_eVA1:
s_cmp_ge_u32 s58, 2
s_cbranch_scc1 L_m6VA1
s_waitcnt vmcnt(4)
buffer_load_dwordx4 v[204:207], v1, s[28:31], s49 offen offset:0 nt
s_waitcnt vmcnt(4)
buffer_load_dwordx4 v[208:211], v250, s[28:31], s49 offen offset:0 nt
s_waitcnt vmcnt(4)
buffer_load_dwordx4 v[212:215], v1, s[28:31], s49 offen offset:2048 nt
s_waitcnt vmcnt(4)
buffer_load_dwordx4 v[216:219], v250, s[28:31], s49 offen offset:2048 nt
s_branch L_fVA1
L_m6VA1:
s_waitcnt vmcnt(5)
buffer_load_dwordx4 v[204:207], v1, s[28:31], s49 offen offset:0 nt
s_waitcnt vmcnt(5)
buffer_load_dwordx4 v[208:211], v250, s[28:31], s49 offen offset:0 nt
s_waitcnt vmcnt(5)
buffer_load_dwordx4 v[212:215], v1, s[28:31], s49 offen offset:2048 nt
s_waitcnt vmcnt(5)
buffer_load_dwordx4 v[216:219], v250, s[28:31], s49 offen offset:2048 nt
L_fVA1:
v_perm_b32 v46, v128, v124, s42
v_perm_b32 v50, v128, v124, s43
v_perm_b32 v54, v129, v125, s42
v_perm_b32 v58, v129, v125, s43
v_perm_b32 v62, v130, v126, s42
v_perm_b32 v66, v130, v126, s43
v_perm_b32 v70, v131, v127, s42
v_perm_b32 v74, v131, v127, s43
v_perm_b32 v47, v136, v132, s42
v_perm_b32 v51, v136, v132, s43
v_perm_b32 v55, v137, v133, s42
v_perm_b32 v59, v137, v133, s43
v_perm_b32 v63, v138, v134, s42
v_perm_b32 v67, v138, v134, s43
v_perm_b32 v71, v139, v135, s42
v_perm_b32 v75, v139, v135, s43
s_cmp_ge_u32 s51, 6
s_cbranch_scc0 L_eVA2
s_cmp_eq_u32 s51, 7
s_cbranch_scc0 L_7VA2
s_waitcnt vmcnt(15)
buffer_load_dwordx4 v[220:223], v1, s[28:31], s50 offen offset:0 nt
s_waitcnt vmcnt(15)
buffer_load_dwordx4 v[224:227], v250, s[28:31], s50 offen offset:0 nt
s_waitcnt vmcnt(15)
buffer_load_dwordx4 v[228:231], v1, s[28:31], s50 offen offset:2048 nt
s_waitcnt vmcnt(15)
buffer_load_dwordx4 v[232:235], v250, s[28:31], s50 offen offset:2048 nt
s_branch L_fVA2
L_7VA2:
s_waitcnt vmcnt(6)
buffer_load_dwordx4 v[220:223], v1, s[28:31], s50 offen offset:0 nt
s_waitcnt vmcnt(6)
buffer_load_dwordx4 v[224:227], v250, s[28:31], s50 offen offset:0 nt
s_waitcnt vmcnt(6)
buffer_load_dwordx4 v[228:231], v1, s[28:31], s50 offen offset:2048 nt
s_waitcnt vmcnt(6)
buffer_load_dwordx4 v[232:235], v250, s[28:31], s50 offen offset:2048 nt
s_branch L_fVA2
L_eVA2:
s_cmp_ge_u32 s58, 2
s_cbranch_scc1 L_m6VA2
s_waitcnt vmcnt(4)
buffer_load_dwordx4 v[220:223], v1, s[28:31], s50 offen offset:0 nt
s_waitcnt vmcnt(4)
buffer_load_dwordx4 v[224:227], v250, s[28:31], s50 offen offset:0 nt
s_waitcnt vmcnt(4)
buffer_load_dwordx4 v[228:231], v1, s[28:31], s50 offen offset:2048 nt
s_waitcnt vmcnt(4)
buffer_load_dwordx4 v[232:235], v250, s[28:31], s50 offen offset:2048 nt
s_branch L_fVA2
L_m6VA2:
s_waitcnt vmcnt(5)
buffer_load_dwordx4 v[220:223], v1, s[28:31], s50 offen offset:0 nt
s_waitcnt vmcnt(5)
buffer_load_dwordx4 v[224:227], v250, s[28:31], s50 offen offset:0 nt
s_waitcnt vmcnt(5)
buffer_load_dwordx4 v[228:231], v1, s[28:31], s50 offen offset:2048 nt
s_waitcnt vmcnt(5)
buffer_load_dwordx4 v[232:235], v250, s[28:31], s50 offen offset:2048 nt
L_fVA2:
s_add_u32 s49, s49, 65536
s_add_u32 s50, s50, 65536
v_mfma_f32_16x16x32_bf16 v[76:79], v[44:47], v[24:27], v[76:79]
v_mfma_f32_16x16x32_bf16 v[80:83], v[48:51], v[24:27], v[80:83]
v_mfma_f32_16x16x32_bf16 v[84:87], v[52:55], v[24:27], v[84:87]
v_mfma_f32_16x16x32_bf16 v[88:91], v[56:59], v[24:27], v[88:91]
v_mfma_f32_16x16x32_bf16 v[92:95], v[60:63], v[24:27], v[92:95]
v_mfma_f32_16x16x32_bf16 v[96:99], v[64:67], v[24:27], v[96:99]
v_mfma_f32_16x16x32_bf16 v[100:103], v[68:71], v[24:27], v[100:103]
v_mfma_f32_16x16x32_bf16 v[104:107], v[72:75], v[24:27], v[104:107]
s_cmp_ge_u32 s51, 6
s_cbranch_scc0 L_lb1
s_barrier
L_lb1:
s_waitcnt lgkmcnt(0)
v_lshlrev_b32 v10, 16, v15
v_and_b32 v11, 0xffff0000, v15
v_readfirstlane_b32 s58, v7
ds_read_b32 v15, v251 offset:10640
s_mov_b64 exec, 1
ds_add_u32 v248, v249 offset:10116
s_mov_b64 exec, -1
ds_read_b32 v7, v248 offset:10120
v_fma_f32 v10, v10, s52, v4
v_fma_f32 v11, v11, s52, v4
v_exp_f32 v10, v10
v_exp_f32 v11, v11
v_perm_b32 v44, v144, v140, s42
v_perm_b32 v48, v144, v140, s43
v_perm_b32 v52, v145, v141, s42
v_perm_b32 v56, v145, v141, s43
v_perm_b32 v60, v146, v142, s42
v_perm_b32 v64, v146, v142, s43
v_perm_b32 v68, v147, v143, s42
v_perm_b32 v72, v147, v143, s43
v_cvt_pk_bf16_f32 v24, v10, v11
v_add_f32 v5, v5, v10
v_add_f32 v5, v5, v11
v_mov_b32_dpp v25, v24 row_shl:4 row_mask:0xf bank_mask:0xf
v_mov_b32_dpp v26, v24 row_shl:8 row_mask:0xf bank_mask:0xf
v_mov_b32_dpp v27, v24 row_shl:12 row_mask:0xf bank_mask:0xf
v_perm_b32 v45, v152, v148, s42
v_perm_b32 v49, v152, v148, s43
v_perm_b32 v53, v153, v149, s42
v_perm_b32 v57, v153, v149, s43
v_perm_b32 v61, v154, v150, s42
v_perm_b32 v65, v154, v150, s43
v_perm_b32 v69, v155, v151, s42
v_perm_b32 v73, v155, v151, s43
s_cmp_eq_u32 s51, 7
s_cbranch_scc1 L_rVA3
s_cmp_ge_u32 s51, 6
s_cbranch_scc0 L_eVA3
s_waitcnt vmcnt(9)
buffer_load_dwordx4 v[108:111], v1, s[28:31], s49 offen offset:0 nt
s_waitcnt vmcnt(9)
buffer_load_dwordx4 v[112:115], v250, s[28:31], s49 offen offset:0 nt
s_waitcnt vmcnt(9)
buffer_load_dwordx4 v[116:119], v1, s[28:31], s49 offen offset:2048 nt
s_waitcnt vmcnt(9)
buffer_load_dwordx4 v[120:123], v250, s[28:31], s49 offen offset:2048 nt
s_branch L_fVA3
L_eVA3:
s_cmp_ge_u32 s58, 2
s_cbranch_scc1 L_m6VA3
s_waitcnt vmcnt(4)
buffer_load_dwordx4 v[108:111], v1, s[28:31], s49 offen offset:0 nt
s_waitcnt vmcnt(4)
buffer_load_dwordx4 v[112:115], v250, s[28:31], s49 offen offset:0 nt
s_waitcnt vmcnt(4)
buffer_load_dwordx4 v[116:119], v1, s[28:31], s49 offen offset:2048 nt
s_waitcnt vmcnt(4)
buffer_load_dwordx4 v[120:123], v250, s[28:31], s49 offen offset:2048 nt
s_branch L_fVA3
L_m6VA3:
s_waitcnt vmcnt(5)
buffer_load_dwordx4 v[108:111], v1, s[28:31], s49 offen offset:0 nt
s_waitcnt vmcnt(5)
buffer_load_dwordx4 v[112:115], v250, s[28:31], s49 offen offset:0 nt
s_waitcnt vmcnt(5)
buffer_load_dwordx4 v[116:119], v1, s[28:31], s49 offen offset:2048 nt
s_waitcnt vmcnt(5)
buffer_load_dwordx4 v[120:123], v250, s[28:31], s49 offen offset:2048 nt
L_fVA3:
L_rVA3:
s_waitcnt vmcnt(16)
v_perm_b32 v46, v160, v156, s42
v_perm_b32 v50, v160, v156, s43
v_perm_b32 v54, v161, v157, s42
v_perm_b32 v58, v161, v157, s43
v_perm_b32 v62, v162, v158, s42
v_perm_b32 v66, v162, v158, s43
v_perm_b32 v70, v163, v159, s42
v_perm_b32 v74, v163, v159, s43
v_perm_b32 v47, v168, v164, s42
v_perm_b32 v51, v168, v164, s43
v_perm_b32 v55, v169, v165, s42
v_perm_b32 v59, v169, v165, s43
v_perm_b32 v63, v170, v166, s42
v_perm_b32 v67, v170, v166, s43
v_perm_b32 v71, v171, v167, s42
v_perm_b32 v75, v171, v167, s43
s_cmp_eq_u32 s51, 7
s_cbranch_scc0 L_xVA4
s_waitcnt vmcnt(12)
s_branch L_rVA4
L_xVA4:
s_cmp_ge_u32 s51, 6
s_cbranch_scc0 L_eVA4
s_waitcnt vmcnt(9)
buffer_load_dwordx4 v[124:127], v1, s[28:31], s50 offen offset:0 nt
s_waitcnt vmcnt(9)
buffer_load_dwordx4 v[128:131], v250, s[28:31], s50 offen offset:0 nt
s_waitcnt vmcnt(9)
buffer_load_dwordx4 v[132:135], v1, s[28:31], s50 offen offset:2048 nt
s_waitcnt vmcnt(9)
buffer_load_dwordx4 v[136:139], v250, s[28:31], s50 offen offset:2048 nt
s_branch L_fVA4
L_eVA4:
s_cmp_ge_u32 s58, 2
s_cbranch_scc1 L_m6VA4
s_waitcnt vmcnt(4)
buffer_load_dwordx4 v[124:127], v1, s[28:31], s50 offen offset:0 nt
s_waitcnt vmcnt(4)
buffer_load_dwordx4 v[128:131], v250, s[28:31], s50 offen offset:0 nt
s_waitcnt vmcnt(4)
buffer_load_dwordx4 v[132:135], v1, s[28:31], s50 offen offset:2048 nt
s_waitcnt vmcnt(4)
buffer_load_dwordx4 v[136:139], v250, s[28:31], s50 offen offset:2048 nt
s_branch L_fVA4
L_m6VA4:
s_waitcnt vmcnt(5)
buffer_load_dwordx4 v[124:127], v1, s[28:31], s50 offen offset:0 nt
s_waitcnt vmcnt(5)
buffer_load_dwordx4 v[128:131], v250, s[28:31], s50 offen offset:0 nt
s_waitcnt vmcnt(5)
buffer_load_dwordx4 v[132:135], v1, s[28:31], s50 offen offset:2048 nt
s_waitcnt vmcnt(5)
buffer_load_dwordx4 v[136:139], v250, s[28:31], s50 offen offset:2048 nt
L_fVA4:
L_rVA4:
s_add_u32 s49, s49, 65536
s_add_u32 s50, s50, 65536
v_mfma_f32_16x16x32_bf16 v[76:79], v[44:47], v[24:27], v[76:79]
v_mfma_f32_16x16x32_bf16 v[80:83], v[48:51], v[24:27], v[80:83]
v_mfma_f32_16x16x32_bf16 v[84:87], v[52:55], v[24:27], v[84:87]
v_mfma_f32_16x16x32_bf16 v[88:91], v[56:59], v[24:27], v[88:91]
v_mfma_f32_16x16x32_bf16 v[92:95], v[60:63], v[24:27], v[92:95]
v_mfma_f32_16x16x32_bf16 v[96:99], v[64:67], v[24:27], v[96:99]
v_mfma_f32_16x16x32_bf16 v[100:103], v[68:71], v[24:27], v[100:103]
v_mfma_f32_16x16x32_bf16 v[104:107], v[72:75], v[24:27], v[104:107]
s_cmp_ge_u32 s51, 6
s_cbranch_scc0 L_lb2
s_barrier
L_lb2:
s_waitcnt lgkmcnt(0)
v_lshlrev_b32 v10, 16, v15
v_and_b32 v11, 0xffff0000, v15
v_readfirstlane_b32 s58, v7
ds_read_b32 v15, v251 offset:10896
s_mov_b64 exec, 1
ds_add_u32 v248, v249 offset:10116
s_mov_b64 exec, -1
ds_read_b32 v7, v248 offset:10120
v_fma_f32 v10, v10, s52, v4
v_fma_f32 v11, v11, s52, v4
v_exp_f32 v10, v10
v_exp_f32 v11, v11
v_perm_b32 v44, v176, v172, s42
v_perm_b32 v48, v176, v172, s43
v_perm_b32 v52, v177, v173, s42
v_perm_b32 v56, v177, v173, s43
v_perm_b32 v60, v178, v174, s42
v_perm_b32 v64, v178, v174, s43
v_perm_b32 v68, v179, v175, s42
v_perm_b32 v72, v179, v175, s43
v_cvt_pk_bf16_f32 v24, v10, v11
v_add_f32 v5, v5, v10
v_add_f32 v5, v5, v11
v_mov_b32_dpp v25, v24 row_shl:4 row_mask:0xf bank_mask:0xf
v_mov_b32_dpp v26, v24 row_shl:8 row_mask:0xf bank_mask:0xf
v_mov_b32_dpp v27, v24 row_shl:12 row_mask:0xf bank_mask:0xf
v_perm_b32 v45, v184, v180, s42
v_perm_b32 v49, v184, v180, s43
v_perm_b32 v53, v185, v181, s42
v_perm_b32 v57, v185, v181, s43
v_perm_b32 v61, v186, v182, s42
v_perm_b32 v65, v186, v182, s43
v_perm_b32 v69, v187, v183, s42
v_perm_b32 v73, v187, v183, s43
s_cmp_eq_u32 s51, 7
s_cbranch_scc0 L_xVB1
s_waitcnt vmcnt(8)
s_branch L_rVB1
L_xVB1:
s_cmp_ge_u32 s51, 6
s_cbranch_scc0 L_eVB1
s_waitcnt vmcnt(15)
buffer_load_dwordx4 v[140:143], v1, s[28:31], s49 offen offset:0 nt
s_waitcnt vmcnt(15)
buffer_load_dwordx4 v[144:147], v250, s[28:31], s49 offen offset:0 nt
s_waitcnt vmcnt(15)
buffer_load_dwordx4 v[148:151], v1, s[28:31], s49 offen offset:2048 nt
s_waitcnt vmcnt(15)
buffer_load_dwordx4 v[152:155], v250, s[28:31], s49 offen offset:2048 nt
s_branch L_fVB1
L_eVB1:
s_cmp_ge_u32 s58, 2
s_cbranch_scc1 L_m6VB1
s_waitcnt vmcnt(4)
buffer_load_dwordx4 v[140:143], v1, s[28:31], s49 offen offset:0 nt
s_waitcnt vmcnt(4)
buffer_load_dwordx4 v[144:147], v250, s[28:31], s49 offen offset:0 nt
s_waitcnt vmcnt(4)
buffer_load_dwordx4 v[148:151], v1, s[28:31], s49 offen offset:2048 nt
s_waitcnt vmcnt(4)
buffer_load_dwordx4 v[152:155], v250, s[28:31], s49 offen offset:2048 nt
s_branch L_fVB1
L_m6VB1:
s_waitcnt vmcnt(5)
buffer_load_dwordx4 v[140:143], v1, s[28:31], s49 offen offset:0 nt
s_waitcnt vmcnt(5)
buffer_load_dwordx4 v[144:147], v250, s[28:31], s49 offen offset:0 nt
s_waitcnt vmcnt(5)
buffer_load_dwordx4 v[148:151], v1, s[28:31], s49 offen offset:2048 nt
s_waitcnt vmcnt(5)
buffer_load_dwordx4 v[152:155], v250, s[28:31], s49 offen offset:2048 nt
L_fVB1:
L_rVB1:
v_perm_b32 v46, v192, v188, s42
v_perm_b32 v50, v192, v188, s43
v_perm_b32 v54, v193, v189, s42
v_perm_b32 v58, v193, v189, s43
v_perm_b32 v62, v194, v190, s42
v_perm_b32 v66, v194, v190, s43
v_perm_b32 v70, v195, v191, s42
v_perm_b32 v74, v195, v191, s43
v_perm_b32 v47, v200, v196, s42
v_perm_b32 v51, v200, v196, s43
v_perm_b32 v55, v201, v197, s42
v_perm_b32 v59, v201, v197, s43
v_perm_b32 v63, v202, v198, s42
v_perm_b32 v67, v202, v198, s43
v_perm_b32 v71, v203, v199, s42
v_perm_b32 v75, v203, v199, s43
s_cmp_eq_u32 s51, 7
s_cbranch_scc1 L_rVB2
s_cmp_ge_u32 s51, 6
s_cbranch_scc0 L_eVB2
s_waitcnt vmcnt(15)
buffer_load_dwordx4 v[156:159], v1, s[28:31], s50 offen offset:0 nt
s_waitcnt vmcnt(15)
buffer_load_dwordx4 v[160:163], v250, s[28:31], s50 offen offset:0 nt
s_waitcnt vmcnt(15)
buffer_load_dwordx4 v[164:167], v1, s[28:31], s50 offen offset:2048 nt
s_waitcnt vmcnt(15)
buffer_load_dwordx4 v[168:171], v250, s[28:31], s50 offen offset:2048 nt
s_branch L_fVB2
L_eVB2:
s_cmp_ge_u32 s58, 2
s_cbranch_scc1 L_m6VB2
s_waitcnt vmcnt(4)
buffer_load_dwordx4 v[156:159], v1, s[28:31], s50 offen offset:0 nt
s_waitcnt vmcnt(4)
buffer_load_dwordx4 v[160:163], v250, s[28:31], s50 offen offset:0 nt
s_waitcnt vmcnt(4)
buffer_load_dwordx4 v[164:167], v1, s[28:31], s50 offen offset:2048 nt
s_waitcnt vmcnt(4)
buffer_load_dwordx4 v[168:171], v250, s[28:31], s50 offen offset:2048 nt
s_branch L_fVB2
L_m6VB2:
s_waitcnt vmcnt(5)
buffer_load_dwordx4 v[156:159], v1, s[28:31], s50 offen offset:0 nt
s_waitcnt vmcnt(5)
buffer_load_dwordx4 v[160:163], v250, s[28:31], s50 offen offset:0 nt
s_waitcnt vmcnt(5)
buffer_load_dwordx4 v[164:167], v1, s[28:31], s50 offen offset:2048 nt
s_waitcnt vmcnt(5)
buffer_load_dwordx4 v[168:171], v250, s[28:31], s50 offen offset:2048 nt
L_fVB2:
L_rVB2:
s_waitcnt vmcnt(63)
s_add_u32 s49, s49, 65536
s_add_u32 s50, s50, 65536
v_mfma_f32_16x16x32_bf16 v[76:79], v[44:47], v[24:27], v[76:79]
v_mfma_f32_16x16x32_bf16 v[80:83], v[48:51], v[24:27], v[80:83]
v_mfma_f32_16x16x32_bf16 v[84:87], v[52:55], v[24:27], v[84:87]
v_mfma_f32_16x16x32_bf16 v[88:91], v[56:59], v[24:27], v[88:91]
v_mfma_f32_16x16x32_bf16 v[92:95], v[60:63], v[24:27], v[92:95]
v_mfma_f32_16x16x32_bf16 v[96:99], v[64:67], v[24:27], v[96:99]
v_mfma_f32_16x16x32_bf16 v[100:103], v[68:71], v[24:27], v[100:103]
v_mfma_f32_16x16x32_bf16 v[104:107], v[72:75], v[24:27], v[104:107]
s_cmp_ge_u32 s51, 6
s_cbranch_scc0 L_lb3
s_cmp_eq_u32 s51, 7
s_cbranch_scc1 L_lb3
s_barrier
L_lb3:
s_waitcnt lgkmcnt(0)
v_lshlrev_b32 v10, 16, v15
v_and_b32 v11, 0xffff0000, v15
v_readfirstlane_b32 s58, v7
ds_read_b32 v15, v251 offset:11152
s_mov_b64 exec, 1
ds_add_u32 v248, v249 offset:10116
s_mov_b64 exec, -1
ds_read_b32 v7, v248 offset:10120
v_fma_f32 v10, v10, s52, v4
v_fma_f32 v11, v11, s52, v4
v_exp_f32 v10, v10
v_exp_f32 v11, v11
s_nop 0
v_cvt_pk_bf16_f32 v24, v10, v11
v_add_f32 v5, v5, v10
v_add_f32 v5, v5, v11
v_mov_b32_dpp v25, v24 row_shl:4 row_mask:0xf bank_mask:0xf
v_mov_b32_dpp v26, v24 row_shl:8 row_mask:0xf bank_mask:0xf
v_mov_b32_dpp v27, v24 row_shl:12 row_mask:0xf bank_mask:0xf
s_cmp_eq_u32 s51, 7
s_cbranch_scc0 L_nw
v_add_f32_dpp v5, v5, v5 row_ror:4 row_mask:0xf bank_mask:0xf
s_nop 1
v_add_f32_dpp v5, v5, v5 row_ror:8 row_mask:0xf bank_mask:0xf
v_mov_b32 v3, v5
s_nop 1
v_permlane16_swap_b32 v5, v3
v_add_f32 v5, v5, v3
v_mov_b32 v3, v5
s_nop 1
v_permlane32_swap_b32 v5, v3
v_add_f32 v5, v5, v3
v_sub_f32 v4, 0, v4
s_mov_b64 exec, 15
ds_write_b64 v237, v[4:5] offset:9728
s_mov_b64 exec, -1
s_waitcnt vmcnt(6)
v_perm_b32 v44, v208, v204, s42
v_perm_b32 v48, v208, v204, s43
v_perm_b32 v52, v209, v205, s42
v_perm_b32 v56, v209, v205, s43
v_perm_b32 v60, v210, v206, s42
v_perm_b32 v64, v210, v206, s43
v_perm_b32 v68, v211, v207, s42
v_perm_b32 v72, v211, v207, s43
s_waitcnt vmcnt(4)
v_perm_b32 v45, v216, v212, s42
v_perm_b32 v49, v216, v212, s43
v_perm_b32 v53, v217, v213, s42
v_perm_b32 v57, v217, v213, s43
v_perm_b32 v61, v218, v214, s42
v_perm_b32 v65, v218, v214, s43
v_perm_b32 v69, v219, v215, s42
v_perm_b32 v73, v219, v215, s43
s_waitcnt vmcnt(2)
v_perm_b32 v46, v224, v220, s42
v_perm_b32 v50, v224, v220, s43
v_perm_b32 v54, v225, v221, s42
v_perm_b32 v58, v225, v221, s43
v_perm_b32 v62, v226, v222, s42
v_perm_b32 v66, v226, v222, s43
v_perm_b32 v70, v227, v223, s42
v_perm_b32 v74, v227, v223, s43
s_waitcnt vmcnt(0)
s_mov_b64 exec, 1
ds_add_u32 v248, v249 offset:10124
s_mov_b64 exec, -1
v_perm_b32 v47, v232, v228, s42
v_perm_b32 v51, v232, v228, s43
v_perm_b32 v55, v233, v229, s42
v_perm_b32 v59, v233, v229, s43
v_perm_b32 v63, v234, v230, s42
v_perm_b32 v67, v234, v230, s43
v_perm_b32 v71, v235, v231, s42
v_perm_b32 v75, v235, v231, s43
v_mfma_f32_16x16x32_bf16 v[76:79], v[44:47], v[24:27], v[76:79]
v_mfma_f32_16x16x32_bf16 v[80:83], v[48:51], v[24:27], v[80:83]
v_mfma_f32_16x16x32_bf16 v[84:87], v[52:55], v[24:27], v[84:87]
v_mfma_f32_16x16x32_bf16 v[88:91], v[56:59], v[24:27], v[88:91]
v_mfma_f32_16x16x32_bf16 v[92:95], v[60:63], v[24:27], v[92:95]
v_mfma_f32_16x16x32_bf16 v[96:99], v[64:67], v[24:27], v[96:99]
v_mfma_f32_16x16x32_bf16 v[100:103], v[68:71], v[24:27], v[100:103]
v_mfma_f32_16x16x32_bf16 v[104:107], v[72:75], v[24:27], v[104:107]
s_branch L_tail
L_nw:
v_perm_b32 v44, v208, v204, s42
v_perm_b32 v48, v208, v204, s43
v_perm_b32 v52, v209, v205, s42
v_perm_b32 v56, v209, v205, s43
v_perm_b32 v60, v210, v206, s42
v_perm_b32 v64, v210, v206, s43
v_perm_b32 v68, v211, v207, s42
v_perm_b32 v72, v211, v207, s43
v_perm_b32 v45, v216, v212, s42
v_perm_b32 v49, v216, v212, s43
v_perm_b32 v53, v217, v213, s42
v_perm_b32 v57, v217, v213, s43
v_perm_b32 v61, v218, v214, s42
v_perm_b32 v65, v218, v214, s43
v_perm_b32 v69, v219, v215, s42
v_perm_b32 v73, v219, v215, s43
s_cmp_ge_u32 s51, 6
s_cbranch_scc0 L_eVB3
s_waitcnt vmcnt(15)
buffer_load_dwordx4 v[172:175], v1, s[28:31], s49 offen offset:0 nt
s_waitcnt vmcnt(15)
buffer_load_dwordx4 v[176:179], v250, s[28:31], s49 offen offset:0 nt
s_waitcnt vmcnt(15)
buffer_load_dwordx4 v[180:183], v1, s[28:31], s49 offen offset:2048 nt
s_waitcnt vmcnt(15)
buffer_load_dwordx4 v[184:187], v250, s[28:31], s49 offen offset:2048 nt
s_branch L_fVB3
L_eVB3:
s_cmp_ge_u32 s58, 2
s_cbranch_scc1 L_m6VB3
s_waitcnt vmcnt(4)
buffer_load_dwordx4 v[172:175], v1, s[28:31], s49 offen offset:0 nt
s_waitcnt vmcnt(4)
buffer_load_dwordx4 v[176:179], v250, s[28:31], s49 offen offset:0 nt
s_waitcnt vmcnt(4)
buffer_load_dwordx4 v[180:183], v1, s[28:31], s49 offen offset:2048 nt
s_waitcnt vmcnt(4)
buffer_load_dwordx4 v[184:187], v250, s[28:31], s49 offen offset:2048 nt
s_branch L_fVB3
L_m6VB3:
s_waitcnt vmcnt(5)
buffer_load_dwordx4 v[172:175], v1, s[28:31], s49 offen offset:0 nt
s_waitcnt vmcnt(5)
buffer_load_dwordx4 v[176:179], v250, s[28:31], s49 offen offset:0 nt
s_waitcnt vmcnt(5)
buffer_load_dwordx4 v[180:183], v1, s[28:31], s49 offen offset:2048 nt
s_waitcnt vmcnt(5)
buffer_load_dwordx4 v[184:187], v250, s[28:31], s49 offen offset:2048 nt
L_fVB3:
v_perm_b32 v46, v224, v220, s42
v_perm_b32 v50, v224, v220, s43
v_perm_b32 v54, v225, v221, s42
v_perm_b32 v58, v225, v221, s43
v_perm_b32 v62, v226, v222, s42
v_perm_b32 v66, v226, v222, s43
v_perm_b32 v70, v227, v223, s42
v_perm_b32 v74, v227, v223, s43
v_perm_b32 v47, v232, v228, s42
v_perm_b32 v51, v232, v228, s43
v_perm_b32 v55, v233, v229, s42
v_perm_b32 v59, v233, v229, s43
v_perm_b32 v63, v234, v230, s42
v_perm_b32 v67, v234, v230, s43
v_perm_b32 v71, v235, v231, s42
v_perm_b32 v75, v235, v231, s43
s_cmp_ge_u32 s51, 6
s_cbranch_scc0 L_eVB4
s_waitcnt vmcnt(15)
buffer_load_dwordx4 v[188:191], v1, s[28:31], s50 offen offset:0 nt
s_waitcnt vmcnt(15)
buffer_load_dwordx4 v[192:195], v250, s[28:31], s50 offen offset:0 nt
s_waitcnt vmcnt(15)
buffer_load_dwordx4 v[196:199], v1, s[28:31], s50 offen offset:2048 nt
s_waitcnt vmcnt(15)
buffer_load_dwordx4 v[200:203], v250, s[28:31], s50 offen offset:2048 nt
s_branch L_fVB4
L_eVB4:
s_cmp_ge_u32 s58, 2
s_cbranch_scc1 L_m6VB4
s_waitcnt vmcnt(4)
buffer_load_dwordx4 v[188:191], v1, s[28:31], s50 offen offset:0 nt
s_waitcnt vmcnt(4)
buffer_load_dwordx4 v[192:195], v250, s[28:31], s50 offen offset:0 nt
s_waitcnt vmcnt(4)
buffer_load_dwordx4 v[196:199], v1, s[28:31], s50 offen offset:2048 nt
s_waitcnt vmcnt(4)
buffer_load_dwordx4 v[200:203], v250, s[28:31], s50 offen offset:2048 nt
s_branch L_fVB4
L_m6VB4:
s_waitcnt vmcnt(5)
buffer_load_dwordx4 v[188:191], v1, s[28:31], s50 offen offset:0 nt
s_waitcnt vmcnt(5)
buffer_load_dwordx4 v[192:195], v250, s[28:31], s50 offen offset:0 nt
s_waitcnt vmcnt(5)
buffer_load_dwordx4 v[196:199], v1, s[28:31], s50 offen offset:2048 nt
s_waitcnt vmcnt(5)
buffer_load_dwordx4 v[200:203], v250, s[28:31], s50 offen offset:2048 nt
L_fVB4:
s_add_u32 s49, s49, 65536
s_add_u32 s50, s50, 65536
v_mfma_f32_16x16x32_bf16 v[76:79], v[44:47], v[24:27], v[76:79]
v_mfma_f32_16x16x32_bf16 v[80:83], v[48:51], v[24:27], v[80:83]
v_mfma_f32_16x16x32_bf16 v[84:87], v[52:55], v[24:27], v[84:87]
v_mfma_f32_16x16x32_bf16 v[88:91], v[56:59], v[24:27], v[88:91]
v_mfma_f32_16x16x32_bf16 v[92:95], v[60:63], v[24:27], v[92:95]
v_mfma_f32_16x16x32_bf16 v[96:99], v[64:67], v[24:27], v[96:99]
v_mfma_f32_16x16x32_bf16 v[100:103], v[68:71], v[24:27], v[100:103]
v_mfma_f32_16x16x32_bf16 v[104:107], v[72:75], v[24:27], v[104:107]
v_add_u32 v251, 1024, v251
s_add_u32 s51, s51, 1
s_branch L_loop
L_tail:
s_mov_b64 exec, s[46:47]
ds_write_b128 v236, v[76:79] offset:1024
ds_write_b128 v236, v[80:83] offset:1040
ds_write_b128 v236, v[84:87] offset:1056
ds_write_b128 v236, v[88:91] offset:1072
ds_write_b128 v236, v[92:95] offset:1088
ds_write_b128 v236, v[96:99] offset:1104
ds_write_b128 v236, v[100:103] offset:1120
ds_write_b128 v236, v[104:107] offset:1136
s_mov_b64 exec, -1
s_waitcnt lgkmcnt(0)
s_barrier
ds_read_b64 v[20:21], v239 offset:9728
ds_read_b64 v[22:23], v239 offset:9760
ds_read_b64 v[24:25], v239 offset:9792
ds_read_b64 v[26:27], v239 offset:9824
ds_read_b128 v[28:31], v238 offset:1024
ds_read_b128 v[32:35], v238 offset:3200
ds_read_b128 v[36:39], v238 offset:5376
ds_read_b128 v[40:43], v238 offset:7552
s_waitcnt lgkmcnt(4)
v_max3_f32 v244, v20, v22, v24
v_max_f32 v244, v244, v26
v_and_b32 v244, s59, v244
v_sub_f32 v20, v20, v244
v_sub_f32 v22, v22, v244
v_sub_f32 v24, v24, v244
v_sub_f32 v26, v26, v244
v_bfi_b32 v244, s59, v244, v14
v_exp_f32 v20, v20
v_exp_f32 v22, v22
v_exp_f32 v24, v24
v_exp_f32 v26, v26
s_waitcnt lgkmcnt(0)
v_mul_f32 v48, v20, v28
v_mul_f32 v49, v20, v29
v_mul_f32 v50, v20, v30
v_mul_f32 v51, v20, v31
v_fmac_f32 v48, v22, v32
v_fmac_f32 v49, v22, v33
v_fmac_f32 v50, v22, v34
v_fmac_f32 v51, v22, v35
v_fmac_f32 v48, v24, v36
v_fmac_f32 v49, v24, v37
v_fmac_f32 v50, v24, v38
v_fmac_f32 v51, v24, v39
v_fmac_f32 v48, v26, v40
v_fmac_f32 v49, v26, v41
v_fmac_f32 v50, v26, v42
v_fmac_f32 v51, v26, v43
v_bfi_b32 v48, s59, v48, v14
v_bfi_b32 v49, s59, v49, v14
v_bfi_b32 v50, s59, v50, v14
v_bfi_b32 v51, s59, v51, v14
s_mov_b32 exec_hi, 0
buffer_store_dwordx4 v[48:51], v240, s[36:39], s60 offen sc1
v_mul_f32 v245, v20, v21
v_fmac_f32 v245, v22, v23
v_fmac_f32 v245, v24, v25
v_fmac_f32 v245, v26, v27
v_bfi_b32 v245, s59, v245, v14
s_mov_b64 exec, 1
buffer_store_dwordx4 v[244:247], off, s[36:39], s61 sc1
s_mov_b64 exec, -1
s_mov_b64 exec, 1
ds_add_u32 v248, v249 offset:10124
s_mov_b64 exec, -1
s_lshr_b32 s56, s2, 7
s_or_b32 s56, s56, s48
s_cbranch_scc0 L_finisher
L_exit:
s_endpgm
L_finisher:
s_mov_b32 s32, s22
s_and_b32 s33, s23, 0xffff
s_mov_b32 s34, 1024
s_mov_b32 s35, 0x20000
v_lshlrev_b32 v12, 16, v12
s_mov_b32 s56, 1507328
s_barrier
L_round:
s_mov_b32 s45, 262144
L_pollF:
buffer_load_dwordx4 v[24:27], v241, s[36:39], s56 offen offset:0 sc1
buffer_load_dwordx4 v[28:31], v241, s[36:39], s56 offen offset:2176 sc1
buffer_load_dwordx4 v[32:35], v242, s[36:39], s56 offen offset:0 sc1
buffer_load_dwordx4 v[36:39], v242, s[36:39], s56 offen offset:2176 sc1
s_sub_u32 s45, s45, 1
s_cbranch_scc1 L_gotF
s_waitcnt vmcnt(0)
v_bitop3_b32 v40, v24, v25, s44 bitop3:0x7e
v_bitop3_b32 v41, v26, v27, s44 bitop3:0x7e
v_bitop3_b32 v42, v28, v29, s44 bitop3:0x7e
v_bitop3_b32 v43, v30, v31, s44 bitop3:0x7e
v_bitop3_b32 v44, v32, v33, s44 bitop3:0x7e
v_bitop3_b32 v45, v34, v35, s44 bitop3:0x7e
v_bitop3_b32 v46, v36, v37, s44 bitop3:0x7e
v_bitop3_b32 v47, v38, v39, s44 bitop3:0x7e
v_or3_b32 v40, v40, v41, v42
v_or3_b32 v43, v43, v44, v45
v_or_b32 v46, v46, v47
v_or3_b32 v40, v40, v43, v46
v_and_b32 v40, 0x3ff, v40
v_cmp_ne_u32 vcc, 0, v40
s_nop 0
s_and_b64 exec, vcc, vcc
s_cbranch_scc1 L_pollF
L_gotF:
s_mov_b64 exec, -1
s_waitcnt vmcnt(0)
v_and_b32 v24, s59, v24
v_and_b32 v25, s59, v25
v_and_b32 v26, s59, v26
v_and_b32 v27, s59, v27
v_and_b32 v28, s59, v28
v_and_b32 v29, s59, v29
v_and_b32 v30, s59, v30
v_and_b32 v31, s59, v31
v_and_b32 v32, s59, v32
v_and_b32 v33, s59, v33
v_and_b32 v34, s59, v34
v_and_b32 v35, s59, v35
v_and_b32 v36, s59, v36
v_and_b32 v37, s59, v37
v_and_b32 v38, s59, v38
v_and_b32 v39, s59, v39
v_add_f32 v24, v24, v28
v_add_f32 v32, v32, v36
v_add_f32 v25, v25, v29
v_add_f32 v33, v33, v37
v_add_f32 v26, v26, v30
v_add_f32 v34, v34, v38
v_add_f32 v27, v27, v31
v_add_f32 v35, v35, v39
v_add_f32 v24, v24, v32
v_add_f32 v25, v25, v33
v_add_f32 v26, v26, v34
v_add_f32 v27, v27, v35
s_nop 0
v_permlane32_swap_b32 v24, v26
v_permlane32_swap_b32 v25, v27
v_add_f32 v24, v24, v26
v_add_f32 v25, v25, v27
s_nop 1
v_permlane16_swap_b32 v24, v25
v_add_f32 v24, v24, v25
s_nop 1
v_add_f32_dpp v24, v24, v24 quad_perm:[1,0,3,2] row_mask:0xf bank_mask:0xf
s_nop 1
v_add_f32_dpp v24, v24, v24 quad_perm:[2,3,0,1] row_mask:0xf bank_mask:0xf
s_nop 1
v_add_f32_dpp v24, v24, v24 row_ror:4 row_mask:0xf bank_mask:0xf
s_nop 1
v_add_f32_dpp v24, v24, v24 row_ror:8 row_mask:0xf bank_mask:0xf
v_cvt_pk_bf16_f32 v24, 0, v24
s_cmp_eq_u32 s56, 950272
s_cbranch_scc1 L_out
v_mov_b32 v50, v24
v_mul_f32 v22, 0xbfb8aa3b, v50
v_exp_f32 v22, v22
s_nop 0
v_add_f32 v22, 1.0, v22
v_rcp_f32 v22, v22
s_nop 0
v_mul_f32 v50, v50, v22
v_cvt_pk_bf16_f32 v50, 0, v50
s_mov_b32 s56, 950272
s_branch L_round
L_out:
v_mul_f32 v24, v24, v50
v_cvt_pk_bf16_f32 v24, 0, v24
v_add_f32 v24, v24, v12
v_cvt_pk_bf16_f32 v24, 0, v24
s_mov_b32 exec_lo, 0x00010001
s_mov_b32 exec_hi, 0x00010001
buffer_store_short_d16_hi v24, v13, s[32:35], 0 offen
s_cmp_lg_u32 s2, 0
s_cbranch_scc1 L_fin2
s_mov_b64 exec, 1
buffer_store_dword v14, off, s[36:39], 0 offset:0
L_fin2:
s_endpgm
L_service:
s_lshr_b32 s40, s2, 5
s_and_b32 s41, s2, 31
s_mov_b32 s86, s2
s_mov_b32 s42, 0x05040100
s_mov_b32 s43, 0x07060302
s_mov_b32 s46, 0x000f000f
s_mov_b32 s47, 0x000f000f
s_mov_b32 s59, 0xfffffc00
v_mov_b32 v4, 0
v_mov_b32 v5, 0
v_mov_b32 v6, 1
v_mov_b32 v7, 0
v_mov_b32 v2, 10112
ds_write_b128 v2, v[4:7]
v_lshrrev_b32 v1, 2, v0
v_and_b32 v56, 3, v0
v_lshlrev_b32 v54, 4, v0
v_lshlrev_b32 v55, 2, v1
v_lshlrev_b32 v50, 14, v1
v_lshl_add_u32 v50, v56, 4, v50
s_bfe_u32 s50, s2, 0x10004
s_bfe_u32 s68, s2, 0x10003
s_and_b32 s55, s2, 7
s_lshl_b32 s55, s55, 1
s_add_u32 s55, s55, s68
s_lshl_b32 s48, s55, 6
s_lshl_b32 s69, s40, 10
s_add_u32 s48, s48, s69
s_lshl_b32 s69, s50, 21
s_add_u32 s48, s48, s69
s_lshl_b32 s69, s50, 9
s_waitcnt lgkmcnt(0)
s_load_dword s44, s[26:27], 0
s_mov_b32 s32, s4
s_and_b32 s33, s5, 0xffff
s_mov_b32 s34, 1024
s_mov_b32 s35, 0x20000
s_mov_b32 s28, s10
s_and_b32 s29, s11, 0xffff
s_mov_b32 s30, 0x400000
s_mov_b32 s31, 0x20000
buffer_load_dwordx4 v[2:5], v54, s[32:35], 0 offen
buffer_load_dword v6, v55, s[32:35], s69 offen offset:0
buffer_load_dword v7, v55, s[32:35], s69 offen offset:64
buffer_load_dword v8, v55, s[32:35], s69 offen offset:128
buffer_load_dword v9, v55, s[32:35], s69 offen offset:192
buffer_load_dword v10, v55, s[32:35], s69 offen offset:256
buffer_load_dword v11, v55, s[32:35], s69 offen offset:320
buffer_load_dword v12, v55, s[32:35], s69 offen offset:384
buffer_load_dword v13, v55, s[32:35], s69 offen offset:448
buffer_load_dwordx4 v[64:67], v50, s[28:31], s48 offen nt
s_add_u32 s48, s48, 8192
buffer_load_dwordx4 v[68:71], v50, s[28:31], s48 offen nt
s_add_u32 s48, s48, 253952
buffer_load_dwordx4 v[72:75], v50, s[28:31], s48 offen nt
s_add_u32 s48, s48, 8192
buffer_load_dwordx4 v[76:79], v50, s[28:31], s48 offen nt
s_add_u32 s48, s48, 253952
buffer_load_dwordx4 v[80:83], v50, s[28:31], s48 offen nt
s_add_u32 s48, s48, 8192
buffer_load_dwordx4 v[84:87], v50, s[28:31], s48 offen nt
s_add_u32 s48, s48, 253952
buffer_load_dwordx4 v[88:91], v50, s[28:31], s48 offen nt
s_add_u32 s48, s48, 8192
buffer_load_dwordx4 v[92:95], v50, s[28:31], s48 offen nt
s_add_u32 s48, s48, 253952
buffer_load_dwordx4 v[96:99], v50, s[28:31], s48 offen nt
s_add_u32 s48, s48, 8192
buffer_load_dwordx4 v[100:103], v50, s[28:31], s48 offen nt
s_add_u32 s48, s48, 253952
buffer_load_dwordx4 v[104:107], v50, s[28:31], s48 offen nt
s_add_u32 s48, s48, 8192
buffer_load_dwordx4 v[108:111], v50, s[28:31], s48 offen nt
s_add_u32 s48, s48, 253952
buffer_load_dwordx4 v[112:115], v50, s[28:31], s48 offen nt
s_add_u32 s48, s48, 8192
buffer_load_dwordx4 v[116:119], v50, s[28:31], s48 offen nt
s_add_u32 s48, s48, 253952
buffer_load_dwordx4 v[120:123], v50, s[28:31], s48 offen nt
s_add_u32 s48, s48, 8192
buffer_load_dwordx4 v[124:127], v50, s[28:31], s48 offen nt
s_barrier
s_mov_b32 s36, s26
s_and_b32 s37, s27, 0xffff
s_mov_b32 s38, 2097152
s_mov_b32 s39, 0x20000
v_lshrrev_b32 v1, 5, v0
v_bfe_u32 v57, v0, 4, 1
v_lshl_add_u32 v1, v1, 1, v57
v_lshl_add_u32 v57, v56, 2, v1
s_lshl_b32 s88, s40, 13
s_add_u32 s88, s88, 65536
s_add_u32 s89, s88, 4096
s_lshl_b32 s62, s50, 12
s_add_u32 s62, s62, s88
s_lshl_b32 s55, s55, 8
s_add_u32 s62, s62, s55
s_waitcnt vmcnt(24)
v_lshlrev_b32 v30, 16, v2
v_and_b32 v31, 0xffff0000, v2
v_lshlrev_b32 v32, 16, v3
v_and_b32 v33, 0xffff0000, v3
v_lshlrev_b32 v34, 16, v4
v_and_b32 v35, 0xffff0000, v4
v_lshlrev_b32 v36, 16, v5
v_and_b32 v37, 0xffff0000, v5
v_add_f32 v2, v30, v31
v_add_f32 v3, v32, v33
v_add_f32 v4, v34, v35
v_add_f32 v5, v36, v37
v_add_f32 v2, v2, v3
v_add_f32 v4, v4, v5
v_add_f32 v2, v2, v4
s_nop 1
v_add_f32_dpp v2, v2, v2 quad_perm:[1,0,3,2] row_mask:0xf bank_mask:0xf
s_nop 1
v_add_f32_dpp v2, v2, v2 quad_perm:[2,3,0,1] row_mask:0xf bank_mask:0xf
s_nop 1
v_add_f32_dpp v2, v2, v2 row_ror:4 row_mask:0xf bank_mask:0xf
s_nop 1
v_add_f32_dpp v2, v2, v2 row_ror:8 row_mask:0xf bank_mask:0xf
v_mov_b32 v54, v2
s_nop 1
v_permlane16_swap_b32 v2, v54
v_add_f32 v2, v2, v54
v_mov_b32 v54, v2
s_nop 1
v_permlane32_swap_b32 v2, v54
v_add_f32 v2, v2, v54
v_mul_f32 v2, 0x3b000000, v2
v_sub_f32 v30, v30, v2
v_sub_f32 v31, v31, v2
v_sub_f32 v32, v32, v2
v_sub_f32 v33, v33, v2
v_sub_f32 v34, v34, v2
v_sub_f32 v35, v35, v2
v_sub_f32 v36, v36, v2
v_sub_f32 v37, v37, v2
v_mul_f32 v3, v30, v30
v_mul_f32 v4, v31, v31
v_fmac_f32 v3, v32, v32
v_fmac_f32 v4, v33, v33
v_fmac_f32 v3, v34, v34
v_fmac_f32 v4, v35, v35
v_fmac_f32 v3, v36, v36
v_fmac_f32 v4, v37, v37
v_add_f32 v3, v3, v4
s_waitcnt vmcnt(16)
v_lshlrev_b32 v14, 16, v6
v_and_b32 v15, 0xffff0000, v6
v_lshlrev_b32 v16, 16, v7
v_and_b32 v17, 0xffff0000, v7
v_lshlrev_b32 v18, 16, v8
v_and_b32 v19, 0xffff0000, v8
v_lshlrev_b32 v20, 16, v9
v_and_b32 v21, 0xffff0000, v9
v_lshlrev_b32 v22, 16, v10
v_and_b32 v23, 0xffff0000, v10
v_lshlrev_b32 v24, 16, v11
v_and_b32 v25, 0xffff0000, v11
v_lshlrev_b32 v26, 16, v12
v_and_b32 v27, 0xffff0000, v12
v_lshlrev_b32 v28, 16, v13
v_and_b32 v29, 0xffff0000, v13
v_add_f32_dpp v3, v3, v3 quad_perm:[1,0,3,2] row_mask:0xf bank_mask:0xf
s_nop 1
v_add_f32_dpp v3, v3, v3 quad_perm:[2,3,0,1] row_mask:0xf bank_mask:0xf
s_nop 1
v_add_f32_dpp v3, v3, v3 row_ror:4 row_mask:0xf bank_mask:0xf
s_nop 1
v_add_f32_dpp v3, v3, v3 row_ror:8 row_mask:0xf bank_mask:0xf
v_mov_b32 v54, v3
s_nop 1
v_permlane16_swap_b32 v3, v54
v_add_f32 v3, v3, v54
v_mov_b32 v54, v3
s_nop 1
v_permlane32_swap_b32 v3, v54
v_add_f32 v3, v3, v54
v_cvt_pk_bf16_f32 v2, 0, v2
v_mul_f32 v3, 0x3b000000, v3
v_cvt_pk_bf16_f32 v3, 0, v3
v_add_f32 v3, 0x3727c5ac, v3
v_cvt_pk_bf16_f32 v3, 0, v3
v_sqrt_f32 v3, v3
v_sub_f32 v14, v14, v2
v_sub_f32 v15, v15, v2
v_sub_f32 v16, v16, v2
v_sub_f32 v17, v17, v2
v_sub_f32 v18, v18, v2
v_sub_f32 v19, v19, v2
v_sub_f32 v20, v20, v2
v_sub_f32 v21, v21, v2
v_sub_f32 v22, v22, v2
v_sub_f32 v23, v23, v2
v_sub_f32 v24, v24, v2
v_sub_f32 v25, v25, v2
v_sub_f32 v26, v26, v2
v_sub_f32 v27, v27, v2
v_sub_f32 v28, v28, v2
v_sub_f32 v29, v29, v2
v_cvt_pk_bf16_f32 v3, 0, v3
v_rcp_f32 v3, v3
v_cvt_pk_bf16_f32 v14, 0, v14
v_cvt_pk_bf16_f32 v15, 0, v15
v_cvt_pk_bf16_f32 v16, 0, v16
v_cvt_pk_bf16_f32 v17, 0, v17
v_cvt_pk_bf16_f32 v18, 0, v18
v_cvt_pk_bf16_f32 v19, 0, v19
v_cvt_pk_bf16_f32 v20, 0, v20
v_cvt_pk_bf16_f32 v21, 0, v21
v_cvt_pk_bf16_f32 v22, 0, v22
v_cvt_pk_bf16_f32 v23, 0, v23
v_cvt_pk_bf16_f32 v24, 0, v24
v_cvt_pk_bf16_f32 v25, 0, v25
v_cvt_pk_bf16_f32 v26, 0, v26
v_cvt_pk_bf16_f32 v27, 0, v27
v_cvt_pk_bf16_f32 v28, 0, v28
v_cvt_pk_bf16_f32 v29, 0, v29
v_mul_f32 v14, v14, v3
v_mul_f32 v15, v15, v3
v_mul_f32 v16, v16, v3
v_mul_f32 v17, v17, v3
v_mul_f32 v18, v18, v3
v_mul_f32 v19, v19, v3
v_mul_f32 v20, v20, v3
v_mul_f32 v21, v21, v3
v_mul_f32 v22, v22, v3
v_mul_f32 v23, v23, v3
v_mul_f32 v24, v24, v3
v_mul_f32 v25, v25, v3
v_mul_f32 v26, v26, v3
v_mul_f32 v27, v27, v3
v_mul_f32 v28, v28, v3
v_mul_f32 v29, v29, v3
v_cvt_pk_bf16_f32 v30, v14, v15
v_cvt_pk_bf16_f32 v31, v16, v17
v_cvt_pk_bf16_f32 v32, v18, v19
v_cvt_pk_bf16_f32 v33, v20, v21
v_cvt_pk_bf16_f32 v34, v22, v23
v_cvt_pk_bf16_f32 v35, v24, v25
v_cvt_pk_bf16_f32 v36, v26, v27
v_cvt_pk_bf16_f32 v37, v28, v29
v_mov_b32 v38, 0
v_mov_b32 v39, 0
v_mov_b32 v40, 0
v_mov_b32 v41, 0
v_mov_b32 v42, 0
v_mov_b32 v43, 0
v_mov_b32 v44, 0
v_mov_b32 v45, 0
s_waitcnt vmcnt(14)
v_perm_b32 v192, v68, v64, s42
v_perm_b32 v193, v68, v64, s43
v_perm_b32 v194, v69, v65, s42
v_perm_b32 v195, v69, v65, s43
v_perm_b32 v196, v70, v66, s42
v_perm_b32 v197, v70, v66, s43
v_perm_b32 v198, v71, v67, s42
v_perm_b32 v199, v71, v67, s43
v_dot2c_f32_bf16 v38, v30, v192
v_dot2c_f32_bf16 v39, v30, v193
v_dot2c_f32_bf16 v40, v30, v194
v_dot2c_f32_bf16 v41, v30, v195
v_dot2c_f32_bf16 v42, v30, v196
v_dot2c_f32_bf16 v43, v30, v197
v_dot2c_f32_bf16 v44, v30, v198
v_dot2c_f32_bf16 v45, v30, v199
s_waitcnt vmcnt(12)
v_perm_b32 v192, v76, v72, s42
v_perm_b32 v193, v76, v72, s43
v_perm_b32 v194, v77, v73, s42
v_perm_b32 v195, v77, v73, s43
v_perm_b32 v196, v78, v74, s42
v_perm_b32 v197, v78, v74, s43
v_perm_b32 v198, v79, v75, s42
v_perm_b32 v199, v79, v75, s43
v_dot2c_f32_bf16 v38, v31, v192
v_dot2c_f32_bf16 v39, v31, v193
v_dot2c_f32_bf16 v40, v31, v194
v_dot2c_f32_bf16 v41, v31, v195
v_dot2c_f32_bf16 v42, v31, v196
v_dot2c_f32_bf16 v43, v31, v197
v_dot2c_f32_bf16 v44, v31, v198
v_dot2c_f32_bf16 v45, v31, v199
s_waitcnt vmcnt(10)
v_perm_b32 v192, v84, v80, s42
v_perm_b32 v193, v84, v80, s43
v_perm_b32 v194, v85, v81, s42
v_perm_b32 v195, v85, v81, s43
v_perm_b32 v196, v86, v82, s42
v_perm_b32 v197, v86, v82, s43
v_perm_b32 v198, v87, v83, s42
v_perm_b32 v199, v87, v83, s43
v_dot2c_f32_bf16 v38, v32, v192
v_dot2c_f32_bf16 v39, v32, v193
v_dot2c_f32_bf16 v40, v32, v194
v_dot2c_f32_bf16 v41, v32, v195
v_dot2c_f32_bf16 v42, v32, v196
v_dot2c_f32_bf16 v43, v32, v197
v_dot2c_f32_bf16 v44, v32, v198
v_dot2c_f32_bf16 v45, v32, v199
s_waitcnt vmcnt(8)
v_perm_b32 v192, v92, v88, s42
v_perm_b32 v193, v92, v88, s43
v_perm_b32 v194, v93, v89, s42
v_perm_b32 v195, v93, v89, s43
v_perm_b32 v196, v94, v90, s42
v_perm_b32 v197, v94, v90, s43
v_perm_b32 v198, v95, v91, s42
v_perm_b32 v199, v95, v91, s43
v_dot2c_f32_bf16 v38, v33, v192
v_dot2c_f32_bf16 v39, v33, v193
v_dot2c_f32_bf16 v40, v33, v194
v_dot2c_f32_bf16 v41, v33, v195
v_dot2c_f32_bf16 v42, v33, v196
v_dot2c_f32_bf16 v43, v33, v197
v_dot2c_f32_bf16 v44, v33, v198
v_dot2c_f32_bf16 v45, v33, v199
s_waitcnt vmcnt(6)
v_perm_b32 v192, v100, v96, s42
v_perm_b32 v193, v100, v96, s43
v_perm_b32 v194, v101, v97, s42
v_perm_b32 v195, v101, v97, s43
v_perm_b32 v196, v102, v98, s42
v_perm_b32 v197, v102, v98, s43
v_perm_b32 v198, v103, v99, s42
v_perm_b32 v199, v103, v99, s43
v_dot2c_f32_bf16 v38, v34, v192
v_dot2c_f32_bf16 v39, v34, v193
v_dot2c_f32_bf16 v40, v34, v194
v_dot2c_f32_bf16 v41, v34, v195
v_dot2c_f32_bf16 v42, v34, v196
v_dot2c_f32_bf16 v43, v34, v197
v_dot2c_f32_bf16 v44, v34, v198
v_dot2c_f32_bf16 v45, v34, v199
s_waitcnt vmcnt(4)
v_perm_b32 v192, v108, v104, s42
v_perm_b32 v193, v108, v104, s43
v_perm_b32 v194, v109, v105, s42
v_perm_b32 v195, v109, v105, s43
v_perm_b32 v196, v110, v106, s42
v_perm_b32 v197, v110, v106, s43
v_perm_b32 v198, v111, v107, s42
v_perm_b32 v199, v111, v107, s43
v_dot2c_f32_bf16 v38, v35, v192
v_dot2c_f32_bf16 v39, v35, v193
v_dot2c_f32_bf16 v40, v35, v194
v_dot2c_f32_bf16 v41, v35, v195
v_dot2c_f32_bf16 v42, v35, v196
v_dot2c_f32_bf16 v43, v35, v197
v_dot2c_f32_bf16 v44, v35, v198
v_dot2c_f32_bf16 v45, v35, v199
s_waitcnt vmcnt(2)
v_perm_b32 v192, v116, v112, s42
v_perm_b32 v193, v116, v112, s43
v_perm_b32 v194, v117, v113, s42
v_perm_b32 v195, v117, v113, s43
v_perm_b32 v196, v118, v114, s42
v_perm_b32 v197, v118, v114, s43
v_perm_b32 v198, v119, v115, s42
v_perm_b32 v199, v119, v115, s43
v_dot2c_f32_bf16 v38, v36, v192
v_dot2c_f32_bf16 v39, v36, v193
v_dot2c_f32_bf16 v40, v36, v194
v_dot2c_f32_bf16 v41, v36, v195
v_dot2c_f32_bf16 v42, v36, v196
v_dot2c_f32_bf16 v43, v36, v197
v_dot2c_f32_bf16 v44, v36, v198
v_dot2c_f32_bf16 v45, v36, v199
s_waitcnt vmcnt(0)
v_perm_b32 v192, v124, v120, s42
v_perm_b32 v193, v124, v120, s43
v_perm_b32 v194, v125, v121, s42
v_perm_b32 v195, v125, v121, s43
v_perm_b32 v196, v126, v122, s42
v_perm_b32 v197, v126, v122, s43
v_perm_b32 v198, v127, v123, s42
v_perm_b32 v199, v127, v123, s43
v_dot2c_f32_bf16 v38, v37, v192
v_dot2c_f32_bf16 v39, v37, v193
v_dot2c_f32_bf16 v40, v37, v194
v_dot2c_f32_bf16 v41, v37, v195
v_dot2c_f32_bf16 v42, v37, v196
v_dot2c_f32_bf16 v43, v37, v197
v_dot2c_f32_bf16 v44, v37, v198
v_dot2c_f32_bf16 v45, v37, v199
v_permlane32_swap_b32 v38, v42
v_permlane32_swap_b32 v39, v43
v_permlane32_swap_b32 v40, v44
v_permlane32_swap_b32 v41, v45
v_add_f32 v38, v38, v42
v_add_f32 v39, v39, v43
v_add_f32 v40, v40, v44
v_add_f32 v41, v41, v45
s_nop 0
v_permlane16_swap_b32 v38, v40
v_permlane16_swap_b32 v39, v41
v_add_f32 v38, v38, v40
v_add_f32 v39, v39, v41
s_nop 0
v_add_f32_dpp v38, v38, v38 row_ror:4 row_mask:0xf bank_mask:0xf
v_add_f32_dpp v39, v39, v39 row_ror:4 row_mask:0xf bank_mask:0xf
s_nop 0
v_add_f32_dpp v38, v38, v38 row_ror:8 row_mask:0xf bank_mask:0xf
v_add_f32_dpp v39, v39, v39 row_ror:8 row_mask:0xf bank_mask:0xf
s_waitcnt lgkmcnt(0)
s_mul_i32 s44, s44, 1664525
s_add_u32 s44, s44, 1013904223
v_mov_b32 v46, v38
v_mov_b32 v47, s44
v_mov_b32 v48, v39
v_mov_b32 v49, s44
v_lshlrev_b32 v1, 4, v57
s_mov_b64 exec, s[46:47]
buffer_store_dwordx4 v[46:49], v1, s[36:39], s62 offen sc1
s_mov_b64 exec, -1
s_and_b32 s90, s2, 7
s_lshr_b32 s69, s2, 5
s_lshl_b32 s69, s69, 3
s_add_u32 s90, s90, s69
s_lshr_b32 s69, s90, 1
s_lshl_b32 s69, s69, 1
s_add_u32 s69, s69, s68
s_bitcmp1_b32 s90, 0
s_cselect_b32 s60, s18, s16
s_cselect_b32 s61, s19, s17
s_cmp_lt_u32 s90, 56
s_cselect_b32 s54, 1835008, 0
s_cselect_b32 s91, 0, 0x7f000000
s_mov_b32 s28, s60
s_and_b32 s29, s61, 0xffff
s_mov_b32 s30, s54
s_mov_b32 s31, 0x20000
v_lshrrev_b32 v1, 2, v0
v_mul_u32_u24 v50, 7168, v1
v_lshl_add_u32 v50, v56, 4, v50
s_mul_i32 s48, s50, 917504
s_lshl_b32 s63, s69, 6
s_add_u32 s48, s48, s63
buffer_load_dwordx4 v[64:67], v50, s[28:31], s48 offen nt
s_add_u32 s48, s48, 3584
buffer_load_dwordx4 v[68:71], v50, s[28:31], s48 offen nt
s_add_u32 s48, s48, 111104
buffer_load_dwordx4 v[72:75], v50, s[28:31], s48 offen nt
s_add_u32 s48, s48, 3584
buffer_load_dwordx4 v[76:79], v50, s[28:31], s48 offen nt
s_add_u32 s48, s48, 111104
buffer_load_dwordx4 v[80:83], v50, s[28:31], s48 offen nt
s_add_u32 s48, s48, 3584
buffer_load_dwordx4 v[84:87], v50, s[28:31], s48 offen nt
s_add_u32 s48, s48, 111104
buffer_load_dwordx4 v[88:91], v50, s[28:31], s48 offen nt
s_add_u32 s48, s48, 3584
buffer_load_dwordx4 v[92:95], v50, s[28:31], s48 offen nt
s_add_u32 s48, s48, 111104
buffer_load_dwordx4 v[96:99], v50, s[28:31], s48 offen nt
s_add_u32 s48, s48, 3584
buffer_load_dwordx4 v[100:103], v50, s[28:31], s48 offen nt
s_add_u32 s48, s48, 111104
buffer_load_dwordx4 v[104:107], v50, s[28:31], s48 offen nt
s_add_u32 s48, s48, 3584
buffer_load_dwordx4 v[108:111], v50, s[28:31], s48 offen nt
s_add_u32 s48, s48, 111104
buffer_load_dwordx4 v[112:115], v50, s[28:31], s48 offen nt
s_add_u32 s48, s48, 3584
buffer_load_dwordx4 v[116:119], v50, s[28:31], s48 offen nt
s_add_u32 s48, s48, 111104
buffer_load_dwordx4 v[120:123], v50, s[28:31], s48 offen nt
s_add_u32 s48, s48, 3584
buffer_load_dwordx4 v[124:127], v50, s[28:31], s48 offen nt
v_mov_b32 v38, 0
v_mov_b32 v39, 0
v_mov_b32 v40, 0
v_mov_b32 v41, 0
v_mov_b32 v42, 0
v_mov_b32 v43, 0
v_mov_b32 v44, 0
v_mov_b32 v45, 0
s_waitcnt vmcnt(14)
v_perm_b32 v192, v68, v64, s42
v_perm_b32 v193, v68, v64, s43
v_perm_b32 v194, v69, v65, s42
v_perm_b32 v195, v69, v65, s43
v_perm_b32 v196, v70, v66, s42
v_perm_b32 v197, v70, v66, s43
v_perm_b32 v198, v71, v67, s42
v_perm_b32 v199, v71, v67, s43
v_dot2c_f32_bf16 v38, v30, v192
v_dot2c_f32_bf16 v39, v30, v193
v_dot2c_f32_bf16 v40, v30, v194
v_dot2c_f32_bf16 v41, v30, v195
v_dot2c_f32_bf16 v42, v30, v196
v_dot2c_f32_bf16 v43, v30, v197
v_dot2c_f32_bf16 v44, v30, v198
v_dot2c_f32_bf16 v45, v30, v199
s_waitcnt vmcnt(12)
v_perm_b32 v192, v76, v72, s42
v_perm_b32 v193, v76, v72, s43
v_perm_b32 v194, v77, v73, s42
v_perm_b32 v195, v77, v73, s43
v_perm_b32 v196, v78, v74, s42
v_perm_b32 v197, v78, v74, s43
v_perm_b32 v198, v79, v75, s42
v_perm_b32 v199, v79, v75, s43
v_dot2c_f32_bf16 v38, v31, v192
v_dot2c_f32_bf16 v39, v31, v193
v_dot2c_f32_bf16 v40, v31, v194
v_dot2c_f32_bf16 v41, v31, v195
v_dot2c_f32_bf16 v42, v31, v196
v_dot2c_f32_bf16 v43, v31, v197
v_dot2c_f32_bf16 v44, v31, v198
v_dot2c_f32_bf16 v45, v31, v199
s_waitcnt vmcnt(10)
v_perm_b32 v192, v84, v80, s42
v_perm_b32 v193, v84, v80, s43
v_perm_b32 v194, v85, v81, s42
v_perm_b32 v195, v85, v81, s43
v_perm_b32 v196, v86, v82, s42
v_perm_b32 v197, v86, v82, s43
v_perm_b32 v198, v87, v83, s42
v_perm_b32 v199, v87, v83, s43
v_dot2c_f32_bf16 v38, v32, v192
v_dot2c_f32_bf16 v39, v32, v193
v_dot2c_f32_bf16 v40, v32, v194
v_dot2c_f32_bf16 v41, v32, v195
v_dot2c_f32_bf16 v42, v32, v196
v_dot2c_f32_bf16 v43, v32, v197
v_dot2c_f32_bf16 v44, v32, v198
v_dot2c_f32_bf16 v45, v32, v199
s_waitcnt vmcnt(8)
v_perm_b32 v192, v92, v88, s42
v_perm_b32 v193, v92, v88, s43
v_perm_b32 v194, v93, v89, s42
v_perm_b32 v195, v93, v89, s43
v_perm_b32 v196, v94, v90, s42
v_perm_b32 v197, v94, v90, s43
v_perm_b32 v198, v95, v91, s42
v_perm_b32 v199, v95, v91, s43
v_dot2c_f32_bf16 v38, v33, v192
v_dot2c_f32_bf16 v39, v33, v193
v_dot2c_f32_bf16 v40, v33, v194
v_dot2c_f32_bf16 v41, v33, v195
v_dot2c_f32_bf16 v42, v33, v196
v_dot2c_f32_bf16 v43, v33, v197
v_dot2c_f32_bf16 v44, v33, v198
v_dot2c_f32_bf16 v45, v33, v199
s_waitcnt vmcnt(6)
v_perm_b32 v192, v100, v96, s42
v_perm_b32 v193, v100, v96, s43
v_perm_b32 v194, v101, v97, s42
v_perm_b32 v195, v101, v97, s43
v_perm_b32 v196, v102, v98, s42
v_perm_b32 v197, v102, v98, s43
v_perm_b32 v198, v103, v99, s42
v_perm_b32 v199, v103, v99, s43
v_dot2c_f32_bf16 v38, v34, v192
v_dot2c_f32_bf16 v39, v34, v193
v_dot2c_f32_bf16 v40, v34, v194
v_dot2c_f32_bf16 v41, v34, v195
v_dot2c_f32_bf16 v42, v34, v196
v_dot2c_f32_bf16 v43, v34, v197
v_dot2c_f32_bf16 v44, v34, v198
v_dot2c_f32_bf16 v45, v34, v199
s_waitcnt vmcnt(4)
v_perm_b32 v192, v108, v104, s42
v_perm_b32 v193, v108, v104, s43
v_perm_b32 v194, v109, v105, s42
v_perm_b32 v195, v109, v105, s43
v_perm_b32 v196, v110, v106, s42
v_perm_b32 v197, v110, v106, s43
v_perm_b32 v198, v111, v107, s42
v_perm_b32 v199, v111, v107, s43
v_dot2c_f32_bf16 v38, v35, v192
v_dot2c_f32_bf16 v39, v35, v193
v_dot2c_f32_bf16 v40, v35, v194
v_dot2c_f32_bf16 v41, v35, v195
v_dot2c_f32_bf16 v42, v35, v196
v_dot2c_f32_bf16 v43, v35, v197
v_dot2c_f32_bf16 v44, v35, v198
v_dot2c_f32_bf16 v45, v35, v199
s_waitcnt vmcnt(2)
v_perm_b32 v192, v116, v112, s42
v_perm_b32 v193, v116, v112, s43
v_perm_b32 v194, v117, v113, s42
v_perm_b32 v195, v117, v113, s43
v_perm_b32 v196, v118, v114, s42
v_perm_b32 v197, v118, v114, s43
v_perm_b32 v198, v119, v115, s42
v_perm_b32 v199, v119, v115, s43
v_dot2c_f32_bf16 v38, v36, v192
v_dot2c_f32_bf16 v39, v36, v193
v_dot2c_f32_bf16 v40, v36, v194
v_dot2c_f32_bf16 v41, v36, v195
v_dot2c_f32_bf16 v42, v36, v196
v_dot2c_f32_bf16 v43, v36, v197
v_dot2c_f32_bf16 v44, v36, v198
v_dot2c_f32_bf16 v45, v36, v199
s_waitcnt vmcnt(0)
v_perm_b32 v192, v124, v120, s42
v_perm_b32 v193, v124, v120, s43
v_perm_b32 v194, v125, v121, s42
v_perm_b32 v195, v125, v121, s43
v_perm_b32 v196, v126, v122, s42
v_perm_b32 v197, v126, v122, s43
v_perm_b32 v198, v127, v123, s42
v_perm_b32 v199, v127, v123, s43
v_dot2c_f32_bf16 v38, v37, v192
v_dot2c_f32_bf16 v39, v37, v193
v_dot2c_f32_bf16 v40, v37, v194
v_dot2c_f32_bf16 v41, v37, v195
v_dot2c_f32_bf16 v42, v37, v196
v_dot2c_f32_bf16 v43, v37, v197
v_dot2c_f32_bf16 v44, v37, v198
v_dot2c_f32_bf16 v45, v37, v199
v_permlane32_swap_b32 v38, v42
v_permlane32_swap_b32 v39, v43
v_permlane32_swap_b32 v40, v44
v_permlane32_swap_b32 v41, v45
v_add_f32 v38, v38, v42
v_add_f32 v39, v39, v43
v_add_f32 v40, v40, v44
v_add_f32 v41, v41, v45
s_nop 0
v_permlane16_swap_b32 v38, v40
v_permlane16_swap_b32 v39, v41
v_add_f32 v38, v38, v40
v_add_f32 v39, v39, v41
s_nop 0
v_add_f32_dpp v38, v38, v38 row_ror:4 row_mask:0xf bank_mask:0xf
v_add_f32_dpp v39, v39, v39 row_ror:4 row_mask:0xf bank_mask:0xf
s_nop 0
v_add_f32_dpp v38, v38, v38 row_ror:8 row_mask:0xf bank_mask:0xf
v_add_f32_dpp v39, v39, v39 row_ror:8 row_mask:0xf bank_mask:0xf
s_and_b32 s60, s90, 1
s_lshl_b32 s60, s60, 1
s_add_u32 s60, s60, s50
s_lshl_b32 s60, s60, 14
s_lshl_b32 s61, s69, 8
s_add_u32 s60, s60, s61
s_add_u32 s60, s60, 131072
s_add_u32 s60, s60, s91
v_lshl_add_u32 v1, v57, 4, s60
v_mov_b32 v46, v38
v_mov_b32 v48, v39
s_mov_b64 exec, s[46:47]
buffer_store_dwordx4 v[46:49], v1, s[36:39], 0 offen sc1
s_mov_b64 exec, -1
v_lshlrev_b32 v1, 4, v0
v_mov_b32 v58, s44
s_mov_b32 s45, 262144
L_pollQ:
buffer_load_dwordx4 v[128:131], v1, s[36:39], s88 offen offset:0 sc1
buffer_load_dwordx4 v[132:135], v1, s[36:39], s88 offen offset:1024 sc1
buffer_load_dwordx4 v[136:139], v1, s[36:39], s88 offen offset:2048 sc1
buffer_load_dwordx4 v[140:143], v1, s[36:39], s88 offen offset:3072 sc1
buffer_load_dwordx4 v[144:147], v1, s[36:39], s89 offen offset:0 sc1
buffer_load_dwordx4 v[148:151], v1, s[36:39], s89 offen offset:1024 sc1
buffer_load_dwordx4 v[152:155], v1, s[36:39], s89 offen offset:2048 sc1
buffer_load_dwordx4 v[156:159], v1, s[36:39], s89 offen offset:3072 sc1
s_sub_u32 s45, s45, 1
s_cbranch_scc1 L_gotQ
s_waitcnt vmcnt(0)
v_bitop3_b32 v192, v129, v131, s44 bitop3:0x7e
v_bitop3_b32 v193, v133, v135, s44 bitop3:0x7e
v_bitop3_b32 v194, v137, v139, s44 bitop3:0x7e
v_bitop3_b32 v195, v141, v143, s44 bitop3:0x7e
v_bitop3_b32 v196, v145, v147, s44 bitop3:0x7e
v_bitop3_b32 v197, v149, v151, s44 bitop3:0x7e
v_bitop3_b32 v198, v153, v155, s44 bitop3:0x7e
v_bitop3_b32 v199, v157, v159, s44 bitop3:0x7e
v_or3_b32 v192, v192, v193, v194
v_or3_b32 v195, v195, v196, v197
v_or_b32 v198, v198, v199
v_or3_b32 v192, v192, v195, v198
v_cmp_ne_u32 vcc, 0, v192
s_nop 0
s_and_b64 exec, vcc, vcc
s_cbranch_scc0 L_gotQ
s_sleep 1
s_branch L_pollQ
L_gotQ:
s_mov_b64 exec, -1
s_waitcnt vmcnt(0)
v_add_f32 v128, v128, v144
v_add_f32 v130, v130, v146
v_add_f32 v132, v132, v148
v_add_f32 v134, v134, v150
v_add_f32 v136, v136, v152
v_add_f32 v138, v138, v154
v_add_f32 v140, v140, v156
v_add_f32 v142, v142, v158
v_lshlrev_b32 v1, 2, v0
v_cvt_pk_bf16_f32 v128, v128, v130
v_cvt_pk_bf16_f32 v132, v132, v134
v_cvt_pk_bf16_f32 v136, v136, v138
v_cvt_pk_bf16_f32 v140, v140, v142
ds_write_b32 v1, v128 offset:0
ds_write_b32 v1, v132 offset:256
ds_write_b32 v1, v136 offset:512
ds_write_b32 v1, v140 offset:768
v_mov_b32 v1, 1
v_mov_b32 v2, 10112
s_waitcnt lgkmcnt(0)
ds_write_b32 v2, v1
s_getreg_b32 s61, hwreg(HW_REG_XCC_ID)
s_and_b32 s61, s61, 7
s_bitcmp1_b32 s61, 0
s_cselect_b32 s66, 13, 11
s_lshl_b32 s61, s61, 11
v_lshl_add_u32 v5, v0, 7, s61
s_lshr_b32 s60, s2, 4
s_lshl_b32 s60, s60, 7
s_add_u32 s60, s60, s61
s_bfe_u32 s87, s2, 0x10003
v_mov_b32 v4, s60
v_mov_b32 v2, 0
s_mov_b32 s68, 3
s_mov_b32 s45, 4194304
s_mov_b64 exec, 0xffff
L_fb:
ds_read_b32 v1, v2 offset:10116
s_lshl_b32 s88, s68, 2
s_add_u32 s64, s88, 4
s_waitcnt lgkmcnt(0)
v_readfirstlane_b32 s89, v1
s_nop 0
s_cmp_ge_u32 s89, s64
s_cbranch_scc1 L_fbgo
s_sub_u32 s45, s45, 1
s_cbranch_scc1 L_fbend
s_sleep 8
s_branch L_fb
L_fbgo:
s_add_u32 s88, s88, 2064384
s_cmp_lg_u32 s87, 0
s_cbranch_scc1 L_nopm
s_mov_b64 exec, 1
buffer_store_dword v58, v4, s[36:39], s88 offen
s_mov_b64 exec, 0xffff
L_nopm:
buffer_load_dword v1, v5, s[36:39], s88 offen sc1
s_waitcnt vmcnt(0)
v_cmp_eq_u32 vcc, s44, v1
s_nop 0
s_bcnt1_i32_b64 s89, vcc
s_cmp_ge_u32 s89, s66
s_cselect_b32 s88, 2, 1
v_mov_b32 v1, s88
ds_write_b32 v2, v1 offset:10120
s_add_u32 s68, s68, 1
s_cmp_lt_u32 s68, 22
s_cbranch_scc1 L_fb
L_fbend:
s_mov_b64 exec, -1
s_mul_i32 s60, s2, 56
s_add_u32 s60, s60, 131072
v_and_b32 v1, 7, v0
v_min_u32 v54, 6, v1
v_lshlrev_b32 v54, 3, v54
v_bfe_u32 v55, v0, 3, 2
v_lshl_add_u32 v54, v55, 14, v54
s_mov_b32 s45, 262144
L_pollH:
buffer_load_dwordx2 v[46:47], v54, s[36:39], s60 offen sc1
s_sub_u32 s45, s45, 1
s_cbranch_scc1 L_gotH
s_waitcnt vmcnt(0)
v_bitop3_b32 v55, v47, v47, s44 bitop3:0x7e
v_cmp_ne_u32 vcc, 0, v55
s_nop 0
s_and_b64 exec, vcc, vcc
s_cbranch_scc0 L_gotH
s_sleep 64
s_branch L_pollH
L_gotH:
s_mov_b64 exec, -1
s_waitcnt vmcnt(0)
v_add_f32_dpp v46, v46, v46 row_ror:8 row_mask:0xf bank_mask:0xf
v_cvt_pk_bf16_f32 v46, 0, v46
v_mov_b32 v47, v46
s_nop 1
v_permlane16_swap_b32 v46, v47
v_mul_f32 v54, 0xbfb8aa3b, v46
v_exp_f32 v54, v54
s_nop 0
v_add_f32 v54, 1.0, v54
v_rcp_f32 v54, v54
s_nop 0
v_mul_f32 v46, v46, v54
v_cvt_pk_bf16_f32 v46, 0, v46
v_mul_f32 v46, v46, v47
v_cvt_pk_bf16_f32 v46, 0, v46
v_cmp_gt_u32 vcc, 7, v1
s_nop 1
v_cndmask_b32 v46, 0, v46, vcc
s_nop 1
v_mov_b32_dpp v47, v46 quad_perm:[1,1,3,3] row_mask:0xf bank_mask:0xf
v_perm_b32 v46, v47, v46, s43
s_nop 0
v_readlane_b32 s64, v46, 0
v_readlane_b32 s65, v46, 2
v_readlane_b32 s66, v46, 4
v_readlane_b32 s67, v46, 6
s_mov_b32 s32, s20
s_and_b32 s33, s21, 0xffff
s_mov_b32 s34, 1835008
s_mov_b32 s35, 0x20000
s_mul_i32 s63, s2, 7168
s_add_u32 s69, s63, 4096
v_lshlrev_b32 v50, 4, v0
v_mov_b32 v92, 0
v_mov_b32 v93, 0
v_mov_b32 v94, 0
v_mov_b32 v95, 0
v_mov_b32 v38, 0
v_mov_b32 v39, 0
v_mov_b32 v40, 0
v_mov_b32 v41, 0
v_mov_b32 v42, 0
v_mov_b32 v43, 0
v_mov_b32 v44, 0
v_mov_b32 v45, 0
L_setup:
s_bfe_u32 s51, s2, 0x20001
s_and_b32 s52, s2, 1
s_lshl_b32 s52, s52, 2
s_bfe_u32 s60, s2, 0x20003
s_add_u32 s52, s52, s60
v_lshrrev_b32 v1, 1, v0
s_lshl_b32 s60, s40, 5
v_add_u32 v1, s60, v1
v_and_b32 v55, 1, v0
s_lshl_b32 s60, s51, 9
s_lshl_b32 s61, s52, 6
s_add_u32 s60, s60, s61
s_add_u32 s60, s60, 393216
v_mul_u32_u24 v51, 2176, v1
v_lshl_add_u32 v51, v55, 5, v51
v_add_u32 v51, s60, v51
s_lshl_b32 s60, s51, 7
s_add_u32 s60, s60, 262144
v_lshl_add_u32 v52, v1, 9, s60
s_mul_i32 s55, s86, 2176
s_add_u32 s60, s55, 950272
v_lshl_add_u32 v53, v0, 4, s60
s_add_u32 s55, s55, 1507328
s_mov_b32 s28, s12
s_and_b32 s29, s13, 0xffff
s_mov_b32 s30, 0x400000
s_mov_b32 s31, 0x20000
s_lshl_b32 s60, s40, 2
s_add_u32 s60, s60, s51
s_lshl_b32 s60, s60, 7
s_lshr_b32 s61, s52, 1
s_lshl_b32 s61, s61, 5
s_add_u32 s60, s60, s61
s_and_b32 s61, s52, 1
s_lshl_b32 s61, s61, 2
s_add_u32 s60, s60, s61
s_lshl_b32 s53, s60, 10
s_add_u32 s60, s53, 8192
s_add_u32 s61, s53, 16384
s_add_u32 s62, s53, 24576
s_waitcnt vmcnt(0) lgkmcnt(0)
L_job:
s_barrier
s_barrier
s_barrier
s_barrier
s_barrier
s_barrier
s_barrier
v_mov_b32 v2, 0
s_mov_b32 s45, 4194304
L_lt:
ds_read_b32 v1, v2 offset:10124
s_sub_u32 s45, s45, 1
s_cbranch_scc1 L_ltgo
s_waitcnt lgkmcnt(0)
v_cmp_gt_u32 vcc, 4, v1
s_cbranch_vccnz L_lt
L_ltgo:
buffer_load_dwordx4 v[64:67], v50, s[32:35], s63 offen offset:0 nt
buffer_load_dwordx4 v[68:71], v50, s[32:35], s63 offen offset:1024 nt
buffer_load_dwordx4 v[72:75], v50, s[32:35], s63 offen offset:2048 nt
buffer_load_dwordx4 v[76:79], v50, s[32:35], s63 offen offset:3072 nt
buffer_load_dwordx4 v[80:83], v50, s[32:35], s69 offen offset:0 nt
buffer_load_dwordx4 v[84:87], v50, s[32:35], s69 offen offset:1024 nt
buffer_load_dwordx4 v[88:91], v50, s[32:35], s69 offen offset:2048 nt
s_barrier
v_mov_b32 v2, 0
s_mov_b32 s45, 4194304
L_lp:
ds_read_b32 v1, v2 offset:10124
s_sub_u32 s45, s45, 1
s_cbranch_scc1 L_lpgo
s_waitcnt lgkmcnt(0)
v_cmp_gt_u32 vcc, 8, v1
s_cbranch_vccnz L_lp
L_lpgo:
buffer_load_dwordx4 v[128:131], v50, s[28:31], s53 offen offset:0 nt
buffer_load_dwordx4 v[132:135], v50, s[28:31], s60 offen offset:0 nt
buffer_load_dwordx4 v[136:139], v50, s[28:31], s61 offen offset:0 nt
buffer_load_dwordx4 v[140:143], v50, s[28:31], s62 offen offset:0 nt
buffer_load_dwordx4 v[144:147], v50, s[28:31], s53 offen offset:1024 nt
buffer_load_dwordx4 v[148:151], v50, s[28:31], s60 offen offset:1024 nt
buffer_load_dwordx4 v[152:155], v50, s[28:31], s61 offen offset:1024 nt
buffer_load_dwordx4 v[156:159], v50, s[28:31], s62 offen offset:1024 nt
buffer_load_dwordx4 v[160:163], v50, s[28:31], s53 offen offset:2048 nt
buffer_load_dwordx4 v[164:167], v50, s[28:31], s60 offen offset:2048 nt
buffer_load_dwordx4 v[168:171], v50, s[28:31], s61 offen offset:2048 nt
buffer_load_dwordx4 v[172:175], v50, s[28:31], s62 offen offset:2048 nt
buffer_load_dwordx4 v[176:179], v50, s[28:31], s53 offen offset:3072 nt
buffer_load_dwordx4 v[180:183], v50, s[28:31], s60 offen offset:3072 nt
buffer_load_dwordx4 v[184:187], v50, s[28:31], s61 offen offset:3072 nt
buffer_load_dwordx4 v[188:191], v50, s[28:31], s62 offen offset:3072 nt
s_waitcnt vmcnt(21)
v_perm_b32 v96, v68, v64, s42
v_perm_b32 v97, v68, v64, s43
v_perm_b32 v98, v69, v65, s42
v_perm_b32 v99, v69, v65, s43
v_perm_b32 v100, v70, v66, s42
v_perm_b32 v101, v70, v66, s43
v_perm_b32 v102, v71, v67, s42
v_perm_b32 v103, v71, v67, s43
v_dot2c_f32_bf16 v38, s64, v96
v_dot2c_f32_bf16 v39, s64, v97
v_dot2c_f32_bf16 v40, s64, v98
v_dot2c_f32_bf16 v41, s64, v99
v_dot2c_f32_bf16 v42, s64, v100
v_dot2c_f32_bf16 v43, s64, v101
v_dot2c_f32_bf16 v44, s64, v102
v_dot2c_f32_bf16 v45, s64, v103
s_waitcnt vmcnt(19)
v_perm_b32 v96, v76, v72, s42
v_perm_b32 v97, v76, v72, s43
v_perm_b32 v98, v77, v73, s42
v_perm_b32 v99, v77, v73, s43
v_perm_b32 v100, v78, v74, s42
v_perm_b32 v101, v78, v74, s43
v_perm_b32 v102, v79, v75, s42
v_perm_b32 v103, v79, v75, s43
v_dot2c_f32_bf16 v38, s65, v96
v_dot2c_f32_bf16 v39, s65, v97
v_dot2c_f32_bf16 v40, s65, v98
v_dot2c_f32_bf16 v41, s65, v99
v_dot2c_f32_bf16 v42, s65, v100
v_dot2c_f32_bf16 v43, s65, v101
v_dot2c_f32_bf16 v44, s65, v102
v_dot2c_f32_bf16 v45, s65, v103
s_waitcnt vmcnt(17)
v_perm_b32 v96, v84, v80, s42
v_perm_b32 v97, v84, v80, s43
v_perm_b32 v98, v85, v81, s42
v_perm_b32 v99, v85, v81, s43
v_perm_b32 v100, v86, v82, s42
v_perm_b32 v101, v86, v82, s43
v_perm_b32 v102, v87, v83, s42
v_perm_b32 v103, v87, v83, s43
v_dot2c_f32_bf16 v38, s66, v96
v_dot2c_f32_bf16 v39, s66, v97
v_dot2c_f32_bf16 v40, s66, v98
v_dot2c_f32_bf16 v41, s66, v99
v_dot2c_f32_bf16 v42, s66, v100
v_dot2c_f32_bf16 v43, s66, v101
v_dot2c_f32_bf16 v44, s66, v102
v_dot2c_f32_bf16 v45, s66, v103
s_waitcnt vmcnt(16)
v_perm_b32 v96, v92, v88, s42
v_perm_b32 v97, v92, v88, s43
v_perm_b32 v98, v93, v89, s42
v_perm_b32 v99, v93, v89, s43
v_perm_b32 v100, v94, v90, s42
v_perm_b32 v101, v94, v90, s43
v_perm_b32 v102, v95, v91, s42
v_perm_b32 v103, v95, v91, s43
v_dot2c_f32_bf16 v38, s67, v96
v_dot2c_f32_bf16 v39, s67, v97
v_dot2c_f32_bf16 v40, s67, v98
v_dot2c_f32_bf16 v41, s67, v99
v_dot2c_f32_bf16 v42, s67, v100
v_dot2c_f32_bf16 v43, s67, v101
v_dot2c_f32_bf16 v44, s67, v102
v_dot2c_f32_bf16 v45, s67, v103
v_bfi_b32 v38, s59, v38, v58
v_bfi_b32 v39, s59, v39, v58
v_bfi_b32 v40, s59, v40, v58
v_bfi_b32 v41, s59, v41, v58
v_bfi_b32 v42, s59, v42, v58
v_bfi_b32 v43, s59, v43, v58
v_bfi_b32 v44, s59, v44, v58
v_bfi_b32 v45, s59, v45, v58
buffer_store_dwordx4 v[38:41], v50, s[36:39], s55 offen sc1
buffer_store_dwordx4 v[42:45], v50, s[36:39], s55 offen offset:1024 sc1
s_waitcnt vmcnt(16)
v_perm_b32 v192, v132, v128, s42
v_perm_b32 v193, v132, v128, s43
v_perm_b32 v194, v133, v129, s42
v_perm_b32 v195, v133, v129, s43
v_perm_b32 v196, v134, v130, s42
v_perm_b32 v197, v134, v130, s43
v_perm_b32 v198, v135, v131, s42
v_perm_b32 v199, v135, v131, s43
s_waitcnt vmcnt(14)
v_perm_b32 v200, v140, v136, s42
v_perm_b32 v201, v140, v136, s43
v_perm_b32 v202, v141, v137, s42
v_perm_b32 v203, v141, v137, s43
v_perm_b32 v204, v142, v138, s42
v_perm_b32 v205, v142, v138, s43
v_perm_b32 v206, v143, v139, s42
v_perm_b32 v207, v143, v139, s43
s_waitcnt vmcnt(12)
v_perm_b32 v208, v148, v144, s42
v_perm_b32 v209, v148, v144, s43
v_perm_b32 v210, v149, v145, s42
v_perm_b32 v211, v149, v145, s43
v_perm_b32 v212, v150, v146, s42
v_perm_b32 v213, v150, v146, s43
v_perm_b32 v214, v151, v147, s42
v_perm_b32 v215, v151, v147, s43
s_waitcnt vmcnt(10)
v_perm_b32 v216, v156, v152, s42
v_perm_b32 v217, v156, v152, s43
v_perm_b32 v218, v157, v153, s42
v_perm_b32 v219, v157, v153, s43
v_perm_b32 v220, v158, v154, s42
v_perm_b32 v221, v158, v154, s43
v_perm_b32 v222, v159, v155, s42
v_perm_b32 v223, v159, v155, s43
s_waitcnt vmcnt(8)
v_perm_b32 v224, v164, v160, s42
v_perm_b32 v225, v164, v160, s43
v_perm_b32 v226, v165, v161, s42
v_perm_b32 v227, v165, v161, s43
v_perm_b32 v228, v166, v162, s42
v_perm_b32 v229, v166, v162, s43
v_perm_b32 v230, v167, v163, s42
v_perm_b32 v231, v167, v163, s43
s_waitcnt vmcnt(6)
v_perm_b32 v232, v172, v168, s42
v_perm_b32 v233, v172, v168, s43
v_perm_b32 v234, v173, v169, s42
v_perm_b32 v235, v173, v169, s43
v_perm_b32 v236, v174, v170, s42
v_perm_b32 v237, v174, v170, s43
v_perm_b32 v238, v175, v171, s42
v_perm_b32 v239, v175, v171, s43
s_waitcnt vmcnt(4)
v_perm_b32 v240, v180, v176, s42
v_perm_b32 v241, v180, v176, s43
v_perm_b32 v242, v181, v177, s42
v_perm_b32 v243, v181, v177, s43
v_perm_b32 v244, v182, v178, s42
v_perm_b32 v245, v182, v178, s43
v_perm_b32 v246, v183, v179, s42
v_perm_b32 v247, v183, v179, s43
s_waitcnt vmcnt(2)
v_perm_b32 v248, v188, v184, s42
v_perm_b32 v249, v188, v184, s43
v_perm_b32 v250, v189, v185, s42
v_perm_b32 v251, v189, v185, s43
v_perm_b32 v252, v190, v186, s42
v_perm_b32 v253, v190, v186, s43
v_perm_b32 v254, v191, v187, s42
v_perm_b32 v255, v191, v187, s43
v_mov_b32 v38, 0
v_mov_b32 v39, 0
v_mov_b32 v40, 0
v_mov_b32 v41, 0
v_mov_b32 v42, 0
v_mov_b32 v43, 0
v_mov_b32 v44, 0
v_mov_b32 v45, 0
s_mov_b32 s45, 262144
L_poll1:
buffer_load_dwordx4 v[112:115], v52, s[36:39], 0 offen sc1
buffer_load_dwordx4 v[104:107], v51, s[36:39], 0 offen sc1
buffer_load_dwordx4 v[108:111], v51, s[36:39], 0 offen offset:16 sc1
s_sub_u32 s45, s45, 1
s_cbranch_scc1 L_got1
s_waitcnt vmcnt(0)
v_bitop3_b32 v14, v104, v105, s44 bitop3:0x7e
v_bitop3_b32 v15, v106, v107, s44 bitop3:0x7e
v_bitop3_b32 v16, v108, v109, s44 bitop3:0x7e
v_bitop3_b32 v17, v110, v111, s44 bitop3:0x7e
v_bitop3_b32 v18, v112, v113, s44 bitop3:0x7e
v_bitop3_b32 v19, v114, v115, s44 bitop3:0x7e
v_or3_b32 v14, v14, v15, v16
v_or3_b32 v17, v17, v18, v19
v_or_b32 v14, v14, v17
v_and_b32 v14, 0x3ff, v14
v_cmp_ne_u32 vcc, 0, v14
s_nop 0
s_and_b64 exec, vcc, vcc
s_cbranch_scc1 L_poll1
L_got1:
s_mov_b64 exec, -1
s_waitcnt vmcnt(0)
s_barrier
v_and_b32 v112, s59, v112
v_and_b32 v104, s59, v104
v_and_b32 v105, s59, v105
v_max_f32_dpp v1, v112, v112 quad_perm:[2,3,0,1] row_mask:0xf bank_mask:0xf
v_and_b32 v106, s59, v106
v_and_b32 v107, s59, v107
v_max_f32_dpp v1, v1, v1 row_ror:4 row_mask:0xf bank_mask:0xf
v_and_b32 v108, s59, v108
v_and_b32 v109, s59, v109
v_max_f32_dpp v1, v1, v1 row_ror:8 row_mask:0xf bank_mask:0xf
v_mov_b32 v54, v1
v_and_b32 v110, s59, v110
v_and_b32 v111, s59, v111
v_permlane16_swap_b32 v1, v54
v_max_f32 v1, v1, v54
v_mov_b32 v54, v1
v_and_b32 v113, s59, v113
s_nop 0
v_permlane32_swap_b32 v1, v54
v_max_f32 v1, v1, v54
v_sub_f32 v1, v112, v1
v_exp_f32 v1, v1
s_nop 0
v_mul_f32 v80, v1, v104
v_mul_f32 v81, v1, v105
v_mul_f32 v82, v1, v106
v_mul_f32 v83, v1, v107
v_mul_f32 v84, v1, v108
v_mul_f32 v85, v1, v109
v_mul_f32 v86, v1, v110
v_mul_f32 v87, v1, v111
v_mul_f32 v89, v1, v113
v_permlane32_swap_b32 v80, v84
v_permlane32_swap_b32 v81, v85
v_permlane32_swap_b32 v82, v86
v_permlane32_swap_b32 v83, v87
v_mov_b32 v54, v89
v_add_f32 v80, v80, v84
v_add_f32 v81, v81, v85
v_add_f32 v82, v82, v86
v_add_f32 v83, v83, v87
v_permlane32_swap_b32 v89, v54
v_permlane16_swap_b32 v80, v82
v_permlane16_swap_b32 v81, v83
v_add_f32 v89, v89, v54
v_add_f32 v80, v80, v82
v_add_f32 v81, v81, v83
v_mov_b32 v54, v89
v_add_f32_dpp v80, v80, v80 quad_perm:[2,3,0,1] row_mask:0xf bank_mask:0xf
v_add_f32_dpp v81, v81, v81 quad_perm:[2,3,0,1] row_mask:0xf bank_mask:0xf
v_permlane16_swap_b32 v89, v54
v_add_f32 v89, v89, v54
v_add_f32_dpp v80, v80, v80 row_ror:4 row_mask:0xf bank_mask:0xf
v_add_f32_dpp v81, v81, v81 row_ror:4 row_mask:0xf bank_mask:0xf
v_add_f32_dpp v89, v89, v89 row_ror:4 row_mask:0xf bank_mask:0xf
v_add_f32_dpp v80, v80, v80 row_ror:8 row_mask:0xf bank_mask:0xf
v_add_f32_dpp v81, v81, v81 row_ror:8 row_mask:0xf bank_mask:0xf
v_add_f32_dpp v89, v89, v89 row_ror:8 row_mask:0xf bank_mask:0xf
s_nop 1
v_add_f32_dpp v89, v89, v89 quad_perm:[2,3,0,1] row_mask:0xf bank_mask:0xf
v_rcp_f32 v89, v89
s_nop 0
v_mul_f32 v80, v80, v89
v_mul_f32 v81, v81, v89
v_cvt_pk_bf16_f32 v46, v80, v81
s_nop 0
v_readlane_b32 s92, v46, 0
v_readlane_b32 s93, v46, 16
v_readlane_b32 s94, v46, 32
v_readlane_b32 s95, v46, 48
v_readlane_b32 s96, v46, 1
v_readlane_b32 s97, v46, 17
v_readlane_b32 s98, v46, 33
v_readlane_b32 s99, v46, 49
v_dot2c_f32_bf16 v38, s92, v192
v_dot2c_f32_bf16 v39, s92, v193
v_dot2c_f32_bf16 v40, s92, v194
v_dot2c_f32_bf16 v41, s92, v195
v_dot2c_f32_bf16 v38, s93, v200
v_dot2c_f32_bf16 v39, s93, v201
v_dot2c_f32_bf16 v40, s93, v202
v_dot2c_f32_bf16 v41, s93, v203
v_dot2c_f32_bf16 v38, s94, v208
v_dot2c_f32_bf16 v39, s94, v209
v_dot2c_f32_bf16 v40, s94, v210
v_dot2c_f32_bf16 v41, s94, v211
v_dot2c_f32_bf16 v38, s95, v216
v_dot2c_f32_bf16 v39, s95, v217
v_dot2c_f32_bf16 v40, s95, v218
v_dot2c_f32_bf16 v41, s95, v219
v_dot2c_f32_bf16 v38, s96, v224
v_dot2c_f32_bf16 v39, s96, v225
v_dot2c_f32_bf16 v40, s96, v226
v_dot2c_f32_bf16 v41, s96, v227
v_dot2c_f32_bf16 v38, s97, v232
v_dot2c_f32_bf16 v39, s97, v233
v_dot2c_f32_bf16 v40, s97, v234
v_dot2c_f32_bf16 v41, s97, v235
v_dot2c_f32_bf16 v38, s98, v240
v_dot2c_f32_bf16 v39, s98, v241
v_dot2c_f32_bf16 v40, s98, v242
v_dot2c_f32_bf16 v41, s98, v243
v_dot2c_f32_bf16 v38, s99, v248
v_dot2c_f32_bf16 v39, s99, v249
v_dot2c_f32_bf16 v40, s99, v250
v_dot2c_f32_bf16 v41, s99, v251
v_bfi_b32 v38, s59, v38, v58
v_bfi_b32 v39, s59, v39, v58
v_bfi_b32 v40, s59, v40, v58
v_bfi_b32 v41, s59, v41, v58
buffer_store_dwordx4 v[38:41], v53, s[36:39], 0 offen offset:0 sc1
v_dot2c_f32_bf16 v42, s92, v196
v_dot2c_f32_bf16 v43, s92, v197
v_dot2c_f32_bf16 v44, s92, v198
v_dot2c_f32_bf16 v45, s92, v199
v_dot2c_f32_bf16 v42, s93, v204
v_dot2c_f32_bf16 v43, s93, v205
v_dot2c_f32_bf16 v44, s93, v206
v_dot2c_f32_bf16 v45, s93, v207
v_dot2c_f32_bf16 v42, s94, v212
v_dot2c_f32_bf16 v43, s94, v213
v_dot2c_f32_bf16 v44, s94, v214
v_dot2c_f32_bf16 v45, s94, v215
v_dot2c_f32_bf16 v42, s95, v220
v_dot2c_f32_bf16 v43, s95, v221
v_dot2c_f32_bf16 v44, s95, v222
v_dot2c_f32_bf16 v45, s95, v223
v_dot2c_f32_bf16 v42, s96, v228
v_dot2c_f32_bf16 v43, s96, v229
v_dot2c_f32_bf16 v44, s96, v230
v_dot2c_f32_bf16 v45, s96, v231
v_dot2c_f32_bf16 v42, s97, v236
v_dot2c_f32_bf16 v43, s97, v237
v_dot2c_f32_bf16 v44, s97, v238
v_dot2c_f32_bf16 v45, s97, v239
v_dot2c_f32_bf16 v42, s98, v244
v_dot2c_f32_bf16 v43, s98, v245
v_dot2c_f32_bf16 v44, s98, v246
v_dot2c_f32_bf16 v45, s98, v247
v_dot2c_f32_bf16 v42, s99, v252
v_dot2c_f32_bf16 v43, s99, v253
v_dot2c_f32_bf16 v44, s99, v254
v_dot2c_f32_bf16 v45, s99, v255
v_bfi_b32 v42, s59, v42, v58
v_bfi_b32 v43, s59, v43, v58
v_bfi_b32 v44, s59, v44, v58
v_bfi_b32 v45, s59, v45, v58
buffer_store_dwordx4 v[42:45], v53, s[36:39], 0 offen offset:1024 sc1
s_endpgm
.section .rodata,"a"
.p2align 6
.amdhsa_kernel recurrent_scan__gqa_block_cached__glu_gated_swiglu__decode_kernel
  .amdhsa_next_free_vgpr 256
  .amdhsa_next_free_sgpr 100
  .amdhsa_accum_offset 256
  .amdhsa_group_segment_fixed_size 0
  .amdhsa_kernarg_size 96
  .amdhsa_user_sgpr_count 2
  .amdhsa_user_sgpr_kernarg_segment_ptr 1
  .amdhsa_system_sgpr_workgroup_id_x 1
  .amdhsa_float_denorm_mode_32 3
.end_amdhsa_kernel
```
